```python
import torch

def _softmax(x, axis=-1):
    return torch.softmax(x, dim=axis)
def _gelu(x):
    return torch.nn.functional.gelu(x, approximate="tanh")
def _silu(x):
    return torch.nn.functional.silu(x)
def _sigmoid(x):
    return torch.sigmoid(x)
def _layernorm(x, axis=-1, eps=1e-5):
    m = x.mean(dim=axis, keepdim=True)
    v = x.var(dim=axis, keepdim=True, unbiased=False)
    return (x - m) / torch.sqrt(v + eps)
def _scatter_add(tgt, idx, src, axis=0):
    return tgt.clone().index_add_(axis, idx, src)
def _segment_sum(src, seg, n):
    out = torch.zeros((n,) + src.shape[1:], dtype=src.dtype)
    return out.index_add_(0, seg, src)
def _pad(x, pw):
    flat = tuple(v for pair in reversed(pw) for v in pair)
    return torch.nn.functional.pad(x, flat)

kernel_name = 'sequential_preLN__ssm_conv_h3__glu_gated_reglu__prompt'

def setup_inputs():

    _w = (lambda a: (lambda t: t.to(torch.bfloat16) if t.is_floating_point() else t)(torch.as_tensor(a)))
    def _A_setup():
        B, S, D = 1, 2048, 512
        ks = 4
        return {
            "q": _w((lambda *s: torch.randn(*s, dtype=torch.bfloat16) * 0.05)(B, S, D)),
            "k": _w((lambda *s: torch.randn(*s, dtype=torch.bfloat16) * 0.2)(B, S, D)),
            "v": _w((lambda *s: torch.randn(*s, dtype=torch.bfloat16) * 0.2)(B, S, D)),
            "shift_k": _w((lambda *s: torch.randn(*s, dtype=torch.bfloat16) * 0.2)(D, ks) * 0.5),
            "ssm_k": _w((lambda *s: torch.randn(*s, dtype=torch.bfloat16) * 0.4)(D, S) * (1.0 / S ** 0.5)),
            "ssm_D": _w((lambda *s: torch.randn(*s, dtype=torch.bfloat16) * 0.2)(D)),
        }
    _A_in = _A_setup()

    def _B_setup():
        B, S, D, F = 1, 2048, 512, 1792
        return {
            "x": _w((lambda *s: torch.randn(*s, dtype=torch.bfloat16) * 0.05)(B, S, D)),
            "W_gate": _w((lambda *s: torch.randn(*s, dtype=torch.bfloat16) * 0.2)(D, F) * (2.0 / D) ** 0.5),
            "W_up": _w((lambda *s: torch.randn(*s, dtype=torch.bfloat16) * 0.2)(D, F) * (2.0 / D) ** 0.5),
            "W_down": _w((lambda *s: torch.randn(*s, dtype=torch.bfloat16) * 0.2)(F, D) * (1.0 / F) ** 0.5),
        }
    _B_in = _B_setup()

    return {
        "A_q": _A_in["q"],
        "A_k": _A_in["k"],
        "A_v": _A_in["v"],
        "A_shift_k": _A_in["shift_k"],
        "A_ssm_k": _A_in["ssm_k"],
        "A_ssm_D": _A_in["ssm_D"],
        "B_x": _B_in["x"],
        "B_W_gate": _B_in["W_gate"],
        "B_W_up": _B_in["W_up"],
        "B_W_down": _B_in["W_down"],
    }

def reference(A_q, A_k, A_v, A_shift_k, A_ssm_k, A_ssm_D, B_x, B_W_gate, B_W_up, B_W_down):
    def _A_ref(q, k, v, shift_k, ssm_k, ssm_D):
        B, S, D = q.shape
        ks = shift_k.shape[-1]
        k_pad = _pad(k, ((0, 0), (ks - 1, 0), (0, 0)))
        k_shift = torch.zeros_like(k)
        for t in range(ks):
            k_shift = k_shift + k_pad[:, t:t + S, :] * shift_k[:, ks - 1 - t][None, None, :]
        kv = k_shift * v
        L = 2 * S
        kv_pad = _pad(kv, ((0, 0), (0, S), (0, 0)))
        kf_pad = _pad(ssm_k, ((0, 0), (0, S)))
        kv_f = (lambda x, axes=(-2,-1): torch.fft.rfft2(x.float(), dim=axes))(kv_pad[:, None, :, :], axes=(1, 2))
        kf_f = (lambda x, axes=(-2,-1): torch.fft.rfft2(x.float(), dim=axes))(kf_pad[:, None, :], axes=(1, 2))
        kf_f = (lambda x, *d: x.permute(*d))(kf_f, 1, 2, 0)
        y_f = kv_f * kf_f[None, :, :, :]
        y = (lambda x, s, axes=(-2,-1): torch.fft.irfft2(x, s=s, dim=axes).to(torch.bfloat16))(y_f, (1, L), axes=(1, 2))[:, 0, :S, :]
        y = y + kv * ssm_D[None, None, :]
        return q * y

    def _B_ref(x, W_gate, W_up, W_down):
        gate = torch.einsum("bsd,df->bsf", x, W_gate)
        up = torch.einsum("bsd,df->bsf", x, W_up)
        gate = gate * (lambda x, dt: x.to(dt))(gate > 0, gate.dtype)
        h = gate * up
        return torch.einsum("bsf,fd->bsd", h, W_down)

    x = A_q
    h = x + _A_ref(_layernorm(x, axis=-1), A_k, A_v, A_shift_k, A_ssm_k, A_ssm_D)
    h2 = h + _B_ref(_layernorm(h, axis=-1), B_W_gate, B_W_up, B_W_down)
    return h2
```

```asm
; @launch kernel=kv_kernel grid=(256,1,1) block=(256,1,1) lds=9216
; @launch kernel=conv_kernel grid=(800,1,1) block=(256,1,1) lds=51712
; @launch kernel=ln_kernel grid=(128,1,1) block=(256,1,1) lds=0
; @launch kernel=g1_kernel grid=(224,1,1) block=(256,1,1) lds=0
; @launch kernel=g2_kernel grid=(256,1,1) block=(256,1,1) lds=0
.amdgcn_target "amdgcn-amd-amdhsa--gfx950"
.text
.globl kv_kernel
.p2align 8
.type kv_kernel,@function
kv_kernel:
    s_cmp_ge_u32 s2, 256
    s_cbranch_scc1 kv_end
    s_load_dwordx4 s[4:7], s[0:1], 8
    s_load_dwordx2 s[8:9], s[0:1], 24
    s_load_dwordx2 s[10:11], s[0:1], 96
    s_waitcnt lgkmcnt(0)
    s_add_u32 s12, s4, 0
    s_addc_u32 s13, s5, 0
    s_mov_b32 s14, 2097152
    s_mov_b32 s15, 0x20000
    s_add_u32 s16, s6, 0
    s_addc_u32 s17, s7, 0
    s_mov_b32 s18, 2097152
    s_mov_b32 s19, 0x20000
    s_add_u32 s20, s8, 0
    s_addc_u32 s21, s9, 0
    s_mov_b32 s22, 4096
    s_mov_b32 s23, 0x20000
    s_add_u32 s24, s10, 0
    s_addc_u32 s25, s11, 0
    s_mov_b32 s26, 2097152
    s_mov_b32 s27, 0x20000
    s_lshr_b32 s28, s2, 3
    s_and_b32 s29, s2, 7
    v_and_b32 v1, 7, v0
    v_lshrrev_b32 v2, 3, v0
    s_lshl_b32 s30, s28, 16
    s_lshl_b32 s31, s29, 7
    s_add_u32 s30, s30, s31
    v_lshlrev_b32 v3, 11, v2
    v_lshl_add_u32 v3, v1, 4, v3
    v_add_u32 v3, s30, v3
    v_add_u32 v4, -3072, v3
    v_add_u32 v5, -2048, v3
    v_add_u32 v6, -1024, v3
    v_add_u32 v7, 0, v3
    v_add_u32 v8, 1024, v3
    buffer_load_dwordx4 v[10:13], v4, s[12:15], 0 offen
    buffer_load_dwordx4 v[14:17], v5, s[12:15], 0 offen
    buffer_load_dwordx4 v[18:21], v6, s[12:15], 0 offen
    buffer_load_dwordx4 v[22:25], v7, s[12:15], 0 offen
    buffer_load_dwordx4 v[26:29], v8, s[12:15], 0 offen
    buffer_load_dwordx4 v[30:33], v3, s[16:19], 0 offen
    buffer_load_dwordx4 v[34:37], v3, s[16:19], 0 offen offset:1024
    s_lshl_b32 s31, s29, 9
    v_lshlrev_b32 v9, 6, v1
    v_add_u32 v9, s31, v9
    buffer_load_dwordx4 v[38:41], v9, s[20:23], 0 offen offset:0
    buffer_load_dwordx4 v[42:45], v9, s[20:23], 0 offen offset:16
    buffer_load_dwordx4 v[46:49], v9, s[20:23], 0 offen offset:32
    buffer_load_dwordx4 v[50:53], v9, s[20:23], 0 offen offset:48
    v_mul_u32_u24 v54, 1152, v1
    v_lshlrev_b32 v55, 2, v2
    v_sub_u32 v54, v54, v55
    v_add_u32 v54, 124, v54
    s_waitcnt vmcnt(0)
    v_lshlrev_b32 v60, 16, v38
    v_and_b32 v61, 0xffff0000, v38
    v_lshlrev_b32 v62, 16, v39
    v_and_b32 v63, 0xffff0000, v39
    v_lshlrev_b32 v64, 16, v40
    v_and_b32 v65, 0xffff0000, v40
    v_lshlrev_b32 v66, 16, v41
    v_and_b32 v67, 0xffff0000, v41
    v_lshlrev_b32 v70, 16, v10
    v_and_b32 v75, 0xffff0000, v10
    v_lshlrev_b32 v71, 16, v14
    v_and_b32 v76, 0xffff0000, v14
    v_lshlrev_b32 v72, 16, v18
    v_and_b32 v77, 0xffff0000, v18
    v_lshlrev_b32 v73, 16, v22
    v_and_b32 v78, 0xffff0000, v22
    v_lshlrev_b32 v74, 16, v26
    v_and_b32 v79, 0xffff0000, v26
    v_lshlrev_b32 v80, 16, v30
    v_and_b32 v82, 0xffff0000, v30
    v_lshlrev_b32 v81, 16, v34
    v_and_b32 v83, 0xffff0000, v34
    v_mul_f32 v84, v70, v63
    v_mul_f32 v85, v75, v67
    v_cvt_pk_bf16_f32 v88, v84, v85
    v_lshlrev_b32 v84, 16, v88
    v_and_b32 v85, 0xffff0000, v88
    v_mul_f32 v86, v71, v62
    v_mul_f32 v87, v76, v66
    v_cvt_pk_bf16_f32 v88, v86, v87
    v_lshlrev_b32 v86, 16, v88
    v_and_b32 v87, 0xffff0000, v88
    v_add_f32 v84, v84, v86
    v_add_f32 v85, v85, v87
    v_cvt_pk_bf16_f32 v88, v84, v85
    v_lshlrev_b32 v84, 16, v88
    v_and_b32 v85, 0xffff0000, v88
    v_mul_f32 v86, v72, v61
    v_mul_f32 v87, v77, v65
    v_cvt_pk_bf16_f32 v88, v86, v87
    v_lshlrev_b32 v86, 16, v88
    v_and_b32 v87, 0xffff0000, v88
    v_add_f32 v84, v84, v86
    v_add_f32 v85, v85, v87
    v_cvt_pk_bf16_f32 v88, v84, v85
    v_lshlrev_b32 v84, 16, v88
    v_and_b32 v85, 0xffff0000, v88
    v_mul_f32 v86, v73, v60
    v_mul_f32 v87, v78, v64
    v_cvt_pk_bf16_f32 v88, v86, v87
    v_lshlrev_b32 v86, 16, v88
    v_and_b32 v87, 0xffff0000, v88
    v_add_f32 v84, v84, v86
    v_add_f32 v85, v85, v87
    v_cvt_pk_bf16_f32 v88, v84, v85
    v_lshlrev_b32 v84, 16, v88
    v_and_b32 v85, 0xffff0000, v88
    v_mul_f32 v90, v84, v80
    v_mul_f32 v92, v85, v82
    v_mul_f32 v84, v71, v63
    v_mul_f32 v85, v76, v67
    v_cvt_pk_bf16_f32 v88, v84, v85
    v_lshlrev_b32 v84, 16, v88
    v_and_b32 v85, 0xffff0000, v88
    v_mul_f32 v86, v72, v62
    v_mul_f32 v87, v77, v66
    v_cvt_pk_bf16_f32 v88, v86, v87
    v_lshlrev_b32 v86, 16, v88
    v_and_b32 v87, 0xffff0000, v88
    v_add_f32 v84, v84, v86
    v_add_f32 v85, v85, v87
    v_cvt_pk_bf16_f32 v88, v84, v85
    v_lshlrev_b32 v84, 16, v88
    v_and_b32 v85, 0xffff0000, v88
    v_mul_f32 v86, v73, v61
    v_mul_f32 v87, v78, v65
    v_cvt_pk_bf16_f32 v88, v86, v87
    v_lshlrev_b32 v86, 16, v88
    v_and_b32 v87, 0xffff0000, v88
    v_add_f32 v84, v84, v86
    v_add_f32 v85, v85, v87
    v_cvt_pk_bf16_f32 v88, v84, v85
    v_lshlrev_b32 v84, 16, v88
    v_and_b32 v85, 0xffff0000, v88
    v_mul_f32 v86, v74, v60
    v_mul_f32 v87, v79, v64
    v_cvt_pk_bf16_f32 v88, v86, v87
    v_lshlrev_b32 v86, 16, v88
    v_and_b32 v87, 0xffff0000, v88
    v_add_f32 v84, v84, v86
    v_add_f32 v85, v85, v87
    v_cvt_pk_bf16_f32 v88, v84, v85
    v_lshlrev_b32 v84, 16, v88
    v_and_b32 v85, 0xffff0000, v88
    v_mul_f32 v91, v84, v81
    v_mul_f32 v93, v85, v83
    v_cvt_pk_bf16_f32 v94, v91, v90
    v_cvt_pk_bf16_f32 v95, v93, v92
    ds_write_b32 v54, v94 offset:0
    ds_write_b32 v54, v95 offset:144
    v_lshlrev_b32 v60, 16, v42
    v_and_b32 v61, 0xffff0000, v42
    v_lshlrev_b32 v62, 16, v43
    v_and_b32 v63, 0xffff0000, v43
    v_lshlrev_b32 v64, 16, v44
    v_and_b32 v65, 0xffff0000, v44
    v_lshlrev_b32 v66, 16, v45
    v_and_b32 v67, 0xffff0000, v45
    v_lshlrev_b32 v70, 16, v11
    v_and_b32 v75, 0xffff0000, v11
    v_lshlrev_b32 v71, 16, v15
    v_and_b32 v76, 0xffff0000, v15
    v_lshlrev_b32 v72, 16, v19
    v_and_b32 v77, 0xffff0000, v19
    v_lshlrev_b32 v73, 16, v23
    v_and_b32 v78, 0xffff0000, v23
    v_lshlrev_b32 v74, 16, v27
    v_and_b32 v79, 0xffff0000, v27
    v_lshlrev_b32 v80, 16, v31
    v_and_b32 v82, 0xffff0000, v31
    v_lshlrev_b32 v81, 16, v35
    v_and_b32 v83, 0xffff0000, v35
    v_mul_f32 v84, v70, v63
    v_mul_f32 v85, v75, v67
    v_cvt_pk_bf16_f32 v88, v84, v85
    v_lshlrev_b32 v84, 16, v88
    v_and_b32 v85, 0xffff0000, v88
    v_mul_f32 v86, v71, v62
    v_mul_f32 v87, v76, v66
    v_cvt_pk_bf16_f32 v88, v86, v87
    v_lshlrev_b32 v86, 16, v88
    v_and_b32 v87, 0xffff0000, v88
    v_add_f32 v84, v84, v86
    v_add_f32 v85, v85, v87
    v_cvt_pk_bf16_f32 v88, v84, v85
    v_lshlrev_b32 v84, 16, v88
    v_and_b32 v85, 0xffff0000, v88
    v_mul_f32 v86, v72, v61
    v_mul_f32 v87, v77, v65
    v_cvt_pk_bf16_f32 v88, v86, v87
    v_lshlrev_b32 v86, 16, v88
    v_and_b32 v87, 0xffff0000, v88
    v_add_f32 v84, v84, v86
    v_add_f32 v85, v85, v87
    v_cvt_pk_bf16_f32 v88, v84, v85
    v_lshlrev_b32 v84, 16, v88
    v_and_b32 v85, 0xffff0000, v88
    v_mul_f32 v86, v73, v60
    v_mul_f32 v87, v78, v64
    v_cvt_pk_bf16_f32 v88, v86, v87
    v_lshlrev_b32 v86, 16, v88
    v_and_b32 v87, 0xffff0000, v88
    v_add_f32 v84, v84, v86
    v_add_f32 v85, v85, v87
    v_cvt_pk_bf16_f32 v88, v84, v85
    v_lshlrev_b32 v84, 16, v88
    v_and_b32 v85, 0xffff0000, v88
    v_mul_f32 v90, v84, v80
    v_mul_f32 v92, v85, v82
    v_mul_f32 v84, v71, v63
    v_mul_f32 v85, v76, v67
    v_cvt_pk_bf16_f32 v88, v84, v85
    v_lshlrev_b32 v84, 16, v88
    v_and_b32 v85, 0xffff0000, v88
    v_mul_f32 v86, v72, v62
    v_mul_f32 v87, v77, v66
    v_cvt_pk_bf16_f32 v88, v86, v87
    v_lshlrev_b32 v86, 16, v88
    v_and_b32 v87, 0xffff0000, v88
    v_add_f32 v84, v84, v86
    v_add_f32 v85, v85, v87
    v_cvt_pk_bf16_f32 v88, v84, v85
    v_lshlrev_b32 v84, 16, v88
    v_and_b32 v85, 0xffff0000, v88
    v_mul_f32 v86, v73, v61
    v_mul_f32 v87, v78, v65
    v_cvt_pk_bf16_f32 v88, v86, v87
    v_lshlrev_b32 v86, 16, v88
    v_and_b32 v87, 0xffff0000, v88
    v_add_f32 v84, v84, v86
    v_add_f32 v85, v85, v87
    v_cvt_pk_bf16_f32 v88, v84, v85
    v_lshlrev_b32 v84, 16, v88
    v_and_b32 v85, 0xffff0000, v88
    v_mul_f32 v86, v74, v60
    v_mul_f32 v87, v79, v64
    v_cvt_pk_bf16_f32 v88, v86, v87
    v_lshlrev_b32 v86, 16, v88
    v_and_b32 v87, 0xffff0000, v88
    v_add_f32 v84, v84, v86
    v_add_f32 v85, v85, v87
    v_cvt_pk_bf16_f32 v88, v84, v85
    v_lshlrev_b32 v84, 16, v88
    v_and_b32 v85, 0xffff0000, v88
    v_mul_f32 v91, v84, v81
    v_mul_f32 v93, v85, v83
    v_cvt_pk_bf16_f32 v94, v91, v90
    v_cvt_pk_bf16_f32 v95, v93, v92
    ds_write_b32 v54, v94 offset:288
    ds_write_b32 v54, v95 offset:432
    v_lshlrev_b32 v60, 16, v46
    v_and_b32 v61, 0xffff0000, v46
    v_lshlrev_b32 v62, 16, v47
    v_and_b32 v63, 0xffff0000, v47
    v_lshlrev_b32 v64, 16, v48
    v_and_b32 v65, 0xffff0000, v48
    v_lshlrev_b32 v66, 16, v49
    v_and_b32 v67, 0xffff0000, v49
    v_lshlrev_b32 v70, 16, v12
    v_and_b32 v75, 0xffff0000, v12
    v_lshlrev_b32 v71, 16, v16
    v_and_b32 v76, 0xffff0000, v16
    v_lshlrev_b32 v72, 16, v20
    v_and_b32 v77, 0xffff0000, v20
    v_lshlrev_b32 v73, 16, v24
    v_and_b32 v78, 0xffff0000, v24
    v_lshlrev_b32 v74, 16, v28
    v_and_b32 v79, 0xffff0000, v28
    v_lshlrev_b32 v80, 16, v32
    v_and_b32 v82, 0xffff0000, v32
    v_lshlrev_b32 v81, 16, v36
    v_and_b32 v83, 0xffff0000, v36
    v_mul_f32 v84, v70, v63
    v_mul_f32 v85, v75, v67
    v_cvt_pk_bf16_f32 v88, v84, v85
    v_lshlrev_b32 v84, 16, v88
    v_and_b32 v85, 0xffff0000, v88
    v_mul_f32 v86, v71, v62
    v_mul_f32 v87, v76, v66
    v_cvt_pk_bf16_f32 v88, v86, v87
    v_lshlrev_b32 v86, 16, v88
    v_and_b32 v87, 0xffff0000, v88
    v_add_f32 v84, v84, v86
    v_add_f32 v85, v85, v87
    v_cvt_pk_bf16_f32 v88, v84, v85
    v_lshlrev_b32 v84, 16, v88
    v_and_b32 v85, 0xffff0000, v88
    v_mul_f32 v86, v72, v61
    v_mul_f32 v87, v77, v65
    v_cvt_pk_bf16_f32 v88, v86, v87
    v_lshlrev_b32 v86, 16, v88
    v_and_b32 v87, 0xffff0000, v88
    v_add_f32 v84, v84, v86
    v_add_f32 v85, v85, v87
    v_cvt_pk_bf16_f32 v88, v84, v85
    v_lshlrev_b32 v84, 16, v88
    v_and_b32 v85, 0xffff0000, v88
    v_mul_f32 v86, v73, v60
    v_mul_f32 v87, v78, v64
    v_cvt_pk_bf16_f32 v88, v86, v87
    v_lshlrev_b32 v86, 16, v88
    v_and_b32 v87, 0xffff0000, v88
    v_add_f32 v84, v84, v86
    v_add_f32 v85, v85, v87
    v_cvt_pk_bf16_f32 v88, v84, v85
    v_lshlrev_b32 v84, 16, v88
    v_and_b32 v85, 0xffff0000, v88
    v_mul_f32 v90, v84, v80
    v_mul_f32 v92, v85, v82
    v_mul_f32 v84, v71, v63
    v_mul_f32 v85, v76, v67
    v_cvt_pk_bf16_f32 v88, v84, v85
    v_lshlrev_b32 v84, 16, v88
    v_and_b32 v85, 0xffff0000, v88
    v_mul_f32 v86, v72, v62
    v_mul_f32 v87, v77, v66
    v_cvt_pk_bf16_f32 v88, v86, v87
    v_lshlrev_b32 v86, 16, v88
    v_and_b32 v87, 0xffff0000, v88
    v_add_f32 v84, v84, v86
    v_add_f32 v85, v85, v87
    v_cvt_pk_bf16_f32 v88, v84, v85
    v_lshlrev_b32 v84, 16, v88
    v_and_b32 v85, 0xffff0000, v88
    v_mul_f32 v86, v73, v61
    v_mul_f32 v87, v78, v65
    v_cvt_pk_bf16_f32 v88, v86, v87
    v_lshlrev_b32 v86, 16, v88
    v_and_b32 v87, 0xffff0000, v88
    v_add_f32 v84, v84, v86
    v_add_f32 v85, v85, v87
    v_cvt_pk_bf16_f32 v88, v84, v85
    v_lshlrev_b32 v84, 16, v88
    v_and_b32 v85, 0xffff0000, v88
    v_mul_f32 v86, v74, v60
    v_mul_f32 v87, v79, v64
    v_cvt_pk_bf16_f32 v88, v86, v87
    v_lshlrev_b32 v86, 16, v88
    v_and_b32 v87, 0xffff0000, v88
    v_add_f32 v84, v84, v86
    v_add_f32 v85, v85, v87
    v_cvt_pk_bf16_f32 v88, v84, v85
    v_lshlrev_b32 v84, 16, v88
    v_and_b32 v85, 0xffff0000, v88
    v_mul_f32 v91, v84, v81
    v_mul_f32 v93, v85, v83
    v_cvt_pk_bf16_f32 v94, v91, v90
    v_cvt_pk_bf16_f32 v95, v93, v92
    ds_write_b32 v54, v94 offset:576
    ds_write_b32 v54, v95 offset:720
    v_lshlrev_b32 v60, 16, v50
    v_and_b32 v61, 0xffff0000, v50
    v_lshlrev_b32 v62, 16, v51
    v_and_b32 v63, 0xffff0000, v51
    v_lshlrev_b32 v64, 16, v52
    v_and_b32 v65, 0xffff0000, v52
    v_lshlrev_b32 v66, 16, v53
    v_and_b32 v67, 0xffff0000, v53
    v_lshlrev_b32 v70, 16, v13
    v_and_b32 v75, 0xffff0000, v13
    v_lshlrev_b32 v71, 16, v17
    v_and_b32 v76, 0xffff0000, v17
    v_lshlrev_b32 v72, 16, v21
    v_and_b32 v77, 0xffff0000, v21
    v_lshlrev_b32 v73, 16, v25
    v_and_b32 v78, 0xffff0000, v25
    v_lshlrev_b32 v74, 16, v29
    v_and_b32 v79, 0xffff0000, v29
    v_lshlrev_b32 v80, 16, v33
    v_and_b32 v82, 0xffff0000, v33
    v_lshlrev_b32 v81, 16, v37
    v_and_b32 v83, 0xffff0000, v37
    v_mul_f32 v84, v70, v63
    v_mul_f32 v85, v75, v67
    v_cvt_pk_bf16_f32 v88, v84, v85
    v_lshlrev_b32 v84, 16, v88
    v_and_b32 v85, 0xffff0000, v88
    v_mul_f32 v86, v71, v62
    v_mul_f32 v87, v76, v66
    v_cvt_pk_bf16_f32 v88, v86, v87
    v_lshlrev_b32 v86, 16, v88
    v_and_b32 v87, 0xffff0000, v88
    v_add_f32 v84, v84, v86
    v_add_f32 v85, v85, v87
    v_cvt_pk_bf16_f32 v88, v84, v85
    v_lshlrev_b32 v84, 16, v88
    v_and_b32 v85, 0xffff0000, v88
    v_mul_f32 v86, v72, v61
    v_mul_f32 v87, v77, v65
    v_cvt_pk_bf16_f32 v88, v86, v87
    v_lshlrev_b32 v86, 16, v88
    v_and_b32 v87, 0xffff0000, v88
    v_add_f32 v84, v84, v86
    v_add_f32 v85, v85, v87
    v_cvt_pk_bf16_f32 v88, v84, v85
    v_lshlrev_b32 v84, 16, v88
    v_and_b32 v85, 0xffff0000, v88
    v_mul_f32 v86, v73, v60
    v_mul_f32 v87, v78, v64
    v_cvt_pk_bf16_f32 v88, v86, v87
    v_lshlrev_b32 v86, 16, v88
    v_and_b32 v87, 0xffff0000, v88
    v_add_f32 v84, v84, v86
    v_add_f32 v85, v85, v87
    v_cvt_pk_bf16_f32 v88, v84, v85
    v_lshlrev_b32 v84, 16, v88
    v_and_b32 v85, 0xffff0000, v88
    v_mul_f32 v90, v84, v80
    v_mul_f32 v92, v85, v82
    v_mul_f32 v84, v71, v63
    v_mul_f32 v85, v76, v67
    v_cvt_pk_bf16_f32 v88, v84, v85
    v_lshlrev_b32 v84, 16, v88
    v_and_b32 v85, 0xffff0000, v88
    v_mul_f32 v86, v72, v62
    v_mul_f32 v87, v77, v66
    v_cvt_pk_bf16_f32 v88, v86, v87
    v_lshlrev_b32 v86, 16, v88
    v_and_b32 v87, 0xffff0000, v88
    v_add_f32 v84, v84, v86
    v_add_f32 v85, v85, v87
    v_cvt_pk_bf16_f32 v88, v84, v85
    v_lshlrev_b32 v84, 16, v88
    v_and_b32 v85, 0xffff0000, v88
    v_mul_f32 v86, v73, v61
    v_mul_f32 v87, v78, v65
    v_cvt_pk_bf16_f32 v88, v86, v87
    v_lshlrev_b32 v86, 16, v88
    v_and_b32 v87, 0xffff0000, v88
    v_add_f32 v84, v84, v86
    v_add_f32 v85, v85, v87
    v_cvt_pk_bf16_f32 v88, v84, v85
    v_lshlrev_b32 v84, 16, v88
    v_and_b32 v85, 0xffff0000, v88
    v_mul_f32 v86, v74, v60
    v_mul_f32 v87, v79, v64
    v_cvt_pk_bf16_f32 v88, v86, v87
    v_lshlrev_b32 v86, 16, v88
    v_and_b32 v87, 0xffff0000, v88
    v_add_f32 v84, v84, v86
    v_add_f32 v85, v85, v87
    v_cvt_pk_bf16_f32 v88, v84, v85
    v_lshlrev_b32 v84, 16, v88
    v_and_b32 v85, 0xffff0000, v88
    v_mul_f32 v91, v84, v81
    v_mul_f32 v93, v85, v83
    v_cvt_pk_bf16_f32 v94, v91, v90
    v_cvt_pk_bf16_f32 v95, v93, v92
    ds_write_b32 v54, v94 offset:864
    ds_write_b32 v54, v95 offset:1008
    s_waitcnt lgkmcnt(0)
    s_barrier
    v_lshrrev_b32 v1, 3, v0
    v_and_b32 v2, 7, v0
    v_mul_u32_u24 v3, 144, v1
    v_lshl_add_u32 v3, v2, 4, v3
    ds_read_b128 v[10:13], v3
    ds_read_b128 v[14:17], v3 offset:4608
    s_lshl_b32 s30, s29, 18
    s_lshl_b32 s31, s28, 7
    s_sub_u32 s30, s30, s31
    s_add_u32 s30, s30, 3968
    v_lshlrev_b32 v4, 12, v1
    v_lshl_add_u32 v4, v2, 4, v4
    v_add_u32 v4, s30, v4
    v_add_u32 v5, 0x20000, v4
    s_waitcnt lgkmcnt(0)
    buffer_store_dwordx4 v[10:13], v4, s[24:27], 0 offen
    buffer_store_dwordx4 v[14:17], v5, s[24:27], 0 offen
kv_end:
    s_endpgm
.globl conv_kernel
.p2align 8
.type conv_kernel,@function
conv_kernel:
    s_cmp_ge_u32 s2, 128
    s_cbranch_scc1 rp_entry
    s_load_dwordx4 s[4:7], s[0:1], 32
    s_load_dwordx2 s[10:11], s[0:1], 96
    s_waitcnt lgkmcnt(0)
    v_lshrrev_b32 v1, 6, v0
    v_and_b32 v2, 63, v0
    s_nop 0
    v_readfirstlane_b32 s28, v1
    s_nop 3
    s_lshl_b32 s29, s2, 2
    s_add_u32 s29, s29, s28
    s_lshl_b32 s30, s29, 12
    s_add_u32 s12, s4, s30
    s_addc_u32 s13, s5, 0
    s_mov_b32 s14, 4096
    s_mov_b32 s15, 0x20000
    s_add_u32 s16, s10, 0
    s_addc_u32 s17, s11, 0
    s_mov_b32 s18, 2097152
    s_mov_b32 s19, 0x20000
    s_add_u32 s24, s10, 2097152
    s_addc_u32 s25, s11, 0
    s_mov_b32 s26, 2097152
    s_mov_b32 s27, 0x20000
    s_add_u32 s20, s6, 0
    s_addc_u32 s21, s7, 0
    s_mov_b32 s22, 1024
    s_mov_b32 s23, 0x20000
    s_lshl_b32 s31, s29, 1
    v_mov_b32 v3, s31
    buffer_load_ushort v200, v3, s[20:23], 0 offen
    s_mul_i32 s32, s28, 4608
    v_lshlrev_b32 v3, 4, v2
    v_add_u32 v4, s30, v3
    v_add_u32 v5, s32, v3
    buffer_load_dwordx4 v[10:13], v4, s[16:19], 0 offen offset:0
    buffer_load_dwordx4 v[30:33], v3, s[12:15], 0 offen offset:0
    buffer_load_dwordx4 v[14:17], v4, s[16:19], 0 offen offset:1024
    buffer_load_dwordx4 v[34:37], v3, s[12:15], 0 offen offset:1024
    buffer_load_dwordx4 v[18:21], v4, s[16:19], 0 offen offset:2048
    buffer_load_dwordx4 v[38:41], v3, s[12:15], 0 offen offset:2048
    buffer_load_dwordx4 v[22:25], v4, s[16:19], 0 offen offset:3072
    buffer_load_dwordx4 v[42:45], v3, s[12:15], 0 offen offset:3072
    s_mul_i32 s33, s28, 4224
    s_add_u32 s33, s33, 34816
    v_mov_b32 v26, 0
    v_mov_b32 v27, 0
    v_mov_b32 v28, 0
    v_mov_b32 v29, 0
    s_waitcnt vmcnt(0)
    ds_write_b128 v5, v[10:13] offset:0
    v_add_u32 v9, s33, v3
    ds_write_b128 v9, v[30:33] offset:64
    ds_write_b128 v5, v[14:17] offset:1024
    v_add_u32 v9, s33, v3
    ds_write_b128 v9, v[34:37] offset:1088
    ds_write_b128 v5, v[18:21] offset:2048
    v_add_u32 v9, s33, v3
    ds_write_b128 v9, v[38:41] offset:2112
    ds_write_b128 v5, v[22:25] offset:3072
    v_add_u32 v9, s33, v3
    ds_write_b128 v9, v[42:45] offset:3136
    v_cmp_gt_u32 vcc, 32, v2
    s_and_saveexec_b64 s[34:35], vcc
    ds_write_b128 v5, v[26:29] offset:4096
    v_cmp_gt_u32 vcc, 4, v2
    s_and_b64 exec, exec, vcc
    ds_write_b128 v9, v[26:29]
    ds_write_b128 v9, v[26:29] offset:4160
    s_mov_b64 exec, s[34:35]
    v_and_b32 v6, 15, v2
    v_lshrrev_b32 v7, 4, v2
    v_lshrrev_b32 v8, 1, v7
    v_and_b32 v9, 1, v7
    v_lshlrev_b32 v10, 4, v8
    v_lshlrev_b32 v11, 3, v9
    v_sub_u32 v10, v10, v11
    v_add_u32 v10, v10, v6
    v_add_u32 v10, -7, v10
    v_and_b32 v11, 1, v10
    v_lshlrev_b32 v11, 4, v11
    v_and_b32 v12, -2, v10
    v_lshlrev_b32 v12, 1, v12
    v_add_u32 v12, s33, v12
    v_add_u32 v12, 64, v12
    v_add_u32 v201, 0, v12
    v_add_u32 v202, 512, v12
    v_add_u32 v203, 1024, v12
    v_add_u32 v204, 1536, v12
    v_add_u32 v205, 2048, v12
    v_add_u32 v206, 2560, v12
    v_add_u32 v207, 3072, v12
    v_add_u32 v208, 3584, v12
    v_lshlrev_b32 v14, 4, v6
    v_sub_u32 v14, 2040, v14
    v_lshl_add_u32 v14, v8, 4, v14
    v_lshlrev_b32 v15, 3, v9
    v_sub_u32 v14, v14, v15
    v_lshlrev_b32 v14, 1, v14
    v_add_u32 v14, s32, v14
    v_add_u32 v14, -3584, v14
    v_mov_b32 v16, 0
    v_mov_b32 v17, 0
    v_mov_b32 v18, 0
    v_mov_b32 v19, 0
    v_mov_b32 v20, 0
    v_mov_b32 v21, 0
    v_mov_b32 v22, 0
    v_mov_b32 v23, 0
    v_mov_b32 v24, 0
    v_mov_b32 v25, 0
    v_mov_b32 v26, 0
    v_mov_b32 v27, 0
    v_mov_b32 v28, 0
    v_mov_b32 v29, 0
    v_mov_b32 v30, 0
    v_mov_b32 v31, 0
    v_mov_b32 v32, 0
    v_mov_b32 v33, 0
    v_mov_b32 v34, 0
    v_mov_b32 v35, 0
    v_mov_b32 v36, 0
    v_mov_b32 v37, 0
    v_mov_b32 v38, 0
    v_mov_b32 v39, 0
    v_mov_b32 v40, 0
    v_mov_b32 v41, 0
    v_mov_b32 v42, 0
    v_mov_b32 v43, 0
    v_mov_b32 v44, 0
    v_mov_b32 v45, 0
    v_mov_b32 v46, 0
    v_mov_b32 v47, 0
    s_waitcnt lgkmcnt(0)
    ds_read2_b32 v[144:145], v201 offset0:0 offset1:1
    ds_read2_b32 v[146:147], v201 offset0:2 offset1:3
    ds_read_b32 v148, v201 offset:16
    ds_read2_b32 v[150:151], v202 offset0:0 offset1:1
    ds_read2_b32 v[152:153], v202 offset0:2 offset1:3
    ds_read_b32 v154, v202 offset:16
    ds_read2_b32 v[156:157], v203 offset0:0 offset1:1
    ds_read2_b32 v[158:159], v203 offset0:2 offset1:3
    ds_read_b32 v160, v203 offset:16
    ds_read2_b32 v[162:163], v204 offset0:0 offset1:1
    ds_read2_b32 v[164:165], v204 offset0:2 offset1:3
    ds_read_b32 v166, v204 offset:16
    ds_read2_b32 v[168:169], v205 offset0:0 offset1:1
    ds_read2_b32 v[170:171], v205 offset0:2 offset1:3
    ds_read_b32 v172, v205 offset:16
    ds_read2_b32 v[174:175], v206 offset0:0 offset1:1
    ds_read2_b32 v[176:177], v206 offset0:2 offset1:3
    ds_read_b32 v178, v206 offset:16
    ds_read2_b32 v[180:181], v207 offset0:0 offset1:1
    ds_read2_b32 v[182:183], v207 offset0:2 offset1:3
    ds_read_b32 v184, v207 offset:16
    ds_read2_b32 v[186:187], v208 offset0:0 offset1:1
    ds_read2_b32 v[188:189], v208 offset0:2 offset1:3
    ds_read_b32 v190, v208 offset:16
    ds_read_b128 v[80:83], v14 offset:3584
    ds_read_b128 v[84:87], v14 offset:3072
    ds_read_b128 v[88:91], v14 offset:2560
    ds_read_b128 v[92:95], v14 offset:2048
    ds_read_b128 v[96:99], v14 offset:1536
    ds_read_b128 v[100:103], v14 offset:1024
    ds_read_b128 v[104:107], v14 offset:512
    ds_read_b128 v[108:111], v14 offset:0
    s_waitcnt lgkmcnt(0)
    v_alignbit_b32 v48, v145, v144, v11
    v_alignbit_b32 v49, v146, v145, v11
    v_alignbit_b32 v50, v147, v146, v11
    v_alignbit_b32 v51, v148, v147, v11
    v_alignbit_b32 v52, v151, v150, v11
    v_alignbit_b32 v53, v152, v151, v11
    v_alignbit_b32 v54, v153, v152, v11
    v_alignbit_b32 v55, v154, v153, v11
    v_alignbit_b32 v56, v157, v156, v11
    v_alignbit_b32 v57, v158, v157, v11
    v_alignbit_b32 v58, v159, v158, v11
    v_alignbit_b32 v59, v160, v159, v11
    v_alignbit_b32 v60, v163, v162, v11
    v_alignbit_b32 v61, v164, v163, v11
    v_alignbit_b32 v62, v165, v164, v11
    v_alignbit_b32 v63, v166, v165, v11
    v_alignbit_b32 v64, v169, v168, v11
    v_alignbit_b32 v65, v170, v169, v11
    v_alignbit_b32 v66, v171, v170, v11
    v_alignbit_b32 v67, v172, v171, v11
    v_alignbit_b32 v68, v175, v174, v11
    v_alignbit_b32 v69, v176, v175, v11
    v_alignbit_b32 v70, v177, v176, v11
    v_alignbit_b32 v71, v178, v177, v11
    v_alignbit_b32 v72, v181, v180, v11
    v_alignbit_b32 v73, v182, v181, v11
    v_alignbit_b32 v74, v183, v182, v11
    v_alignbit_b32 v75, v184, v183, v11
    v_alignbit_b32 v76, v187, v186, v11
    v_alignbit_b32 v77, v188, v187, v11
    v_alignbit_b32 v78, v189, v188, v11
    v_alignbit_b32 v79, v190, v189, v11
    s_waitcnt lgkmcnt(0)
    ds_read2_b32 v[144:145], v201 offset0:16 offset1:17
    ds_read2_b32 v[146:147], v201 offset0:18 offset1:19
    ds_read_b32 v148, v201 offset:80
    ds_read2_b32 v[150:151], v202 offset0:16 offset1:17
    ds_read2_b32 v[152:153], v202 offset0:18 offset1:19
    ds_read_b32 v154, v202 offset:80
    ds_read2_b32 v[156:157], v203 offset0:16 offset1:17
    ds_read2_b32 v[158:159], v203 offset0:18 offset1:19
    ds_read_b32 v160, v203 offset:80
    ds_read2_b32 v[162:163], v204 offset0:16 offset1:17
    ds_read2_b32 v[164:165], v204 offset0:18 offset1:19
    ds_read_b32 v166, v204 offset:80
    ds_read2_b32 v[168:169], v205 offset0:16 offset1:17
    ds_read2_b32 v[170:171], v205 offset0:18 offset1:19
    ds_read_b32 v172, v205 offset:80
    ds_read2_b32 v[174:175], v206 offset0:16 offset1:17
    ds_read2_b32 v[176:177], v206 offset0:18 offset1:19
    ds_read_b32 v178, v206 offset:80
    ds_read2_b32 v[180:181], v207 offset0:16 offset1:17
    ds_read2_b32 v[182:183], v207 offset0:18 offset1:19
    ds_read_b32 v184, v207 offset:80
    ds_read2_b32 v[186:187], v208 offset0:16 offset1:17
    ds_read2_b32 v[188:189], v208 offset0:18 offset1:19
    ds_read_b32 v190, v208 offset:80
    ds_read_b128 v[112:115], v14 offset:3648
    ds_read_b128 v[116:119], v14 offset:3136
    ds_read_b128 v[120:123], v14 offset:2624
    ds_read_b128 v[124:127], v14 offset:2112
    ds_read_b128 v[128:131], v14 offset:1600
    ds_read_b128 v[132:135], v14 offset:1088
    ds_read_b128 v[136:139], v14 offset:576
    ds_read_b128 v[140:143], v14 offset:64
    v_mfma_f32_16x16x32_bf16 v[16:19], v[48:51], v[80:83], v[16:19]
    v_mfma_f32_16x16x32_bf16 v[20:23], v[48:51], v[84:87], v[20:23]
    v_mfma_f32_16x16x32_bf16 v[20:23], v[52:55], v[80:83], v[20:23]
    v_mfma_f32_16x16x32_bf16 v[24:27], v[48:51], v[88:91], v[24:27]
    v_mfma_f32_16x16x32_bf16 v[24:27], v[52:55], v[84:87], v[24:27]
    v_mfma_f32_16x16x32_bf16 v[24:27], v[56:59], v[80:83], v[24:27]
    v_mfma_f32_16x16x32_bf16 v[28:31], v[48:51], v[92:95], v[28:31]
    v_mfma_f32_16x16x32_bf16 v[28:31], v[52:55], v[88:91], v[28:31]
    v_mfma_f32_16x16x32_bf16 v[28:31], v[56:59], v[84:87], v[28:31]
    v_mfma_f32_16x16x32_bf16 v[28:31], v[60:63], v[80:83], v[28:31]
    v_mfma_f32_16x16x32_bf16 v[32:35], v[48:51], v[96:99], v[32:35]
    v_mfma_f32_16x16x32_bf16 v[32:35], v[52:55], v[92:95], v[32:35]
    v_mfma_f32_16x16x32_bf16 v[32:35], v[56:59], v[88:91], v[32:35]
    v_mfma_f32_16x16x32_bf16 v[32:35], v[60:63], v[84:87], v[32:35]
    v_mfma_f32_16x16x32_bf16 v[32:35], v[64:67], v[80:83], v[32:35]
    v_mfma_f32_16x16x32_bf16 v[36:39], v[48:51], v[100:103], v[36:39]
    v_mfma_f32_16x16x32_bf16 v[36:39], v[52:55], v[96:99], v[36:39]
    v_mfma_f32_16x16x32_bf16 v[36:39], v[56:59], v[92:95], v[36:39]
    v_mfma_f32_16x16x32_bf16 v[36:39], v[60:63], v[88:91], v[36:39]
    v_mfma_f32_16x16x32_bf16 v[36:39], v[64:67], v[84:87], v[36:39]
    v_mfma_f32_16x16x32_bf16 v[36:39], v[68:71], v[80:83], v[36:39]
    v_mfma_f32_16x16x32_bf16 v[40:43], v[48:51], v[104:107], v[40:43]
    v_mfma_f32_16x16x32_bf16 v[40:43], v[52:55], v[100:103], v[40:43]
    v_mfma_f32_16x16x32_bf16 v[40:43], v[56:59], v[96:99], v[40:43]
    v_mfma_f32_16x16x32_bf16 v[40:43], v[60:63], v[92:95], v[40:43]
    v_mfma_f32_16x16x32_bf16 v[40:43], v[64:67], v[88:91], v[40:43]
    v_mfma_f32_16x16x32_bf16 v[40:43], v[68:71], v[84:87], v[40:43]
    v_mfma_f32_16x16x32_bf16 v[40:43], v[72:75], v[80:83], v[40:43]
    v_mfma_f32_16x16x32_bf16 v[44:47], v[48:51], v[108:111], v[44:47]
    v_mfma_f32_16x16x32_bf16 v[44:47], v[52:55], v[104:107], v[44:47]
    v_mfma_f32_16x16x32_bf16 v[44:47], v[56:59], v[100:103], v[44:47]
    v_mfma_f32_16x16x32_bf16 v[44:47], v[60:63], v[96:99], v[44:47]
    v_mfma_f32_16x16x32_bf16 v[44:47], v[64:67], v[92:95], v[44:47]
    v_mfma_f32_16x16x32_bf16 v[44:47], v[68:71], v[88:91], v[44:47]
    v_mfma_f32_16x16x32_bf16 v[44:47], v[72:75], v[84:87], v[44:47]
    v_mfma_f32_16x16x32_bf16 v[44:47], v[76:79], v[80:83], v[44:47]
    s_waitcnt lgkmcnt(0)
    v_alignbit_b32 v48, v145, v144, v11
    v_alignbit_b32 v49, v146, v145, v11
    v_alignbit_b32 v50, v147, v146, v11
    v_alignbit_b32 v51, v148, v147, v11
    v_alignbit_b32 v52, v151, v150, v11
    v_alignbit_b32 v53, v152, v151, v11
    v_alignbit_b32 v54, v153, v152, v11
    v_alignbit_b32 v55, v154, v153, v11
    v_alignbit_b32 v56, v157, v156, v11
    v_alignbit_b32 v57, v158, v157, v11
    v_alignbit_b32 v58, v159, v158, v11
    v_alignbit_b32 v59, v160, v159, v11
    v_alignbit_b32 v60, v163, v162, v11
    v_alignbit_b32 v61, v164, v163, v11
    v_alignbit_b32 v62, v165, v164, v11
    v_alignbit_b32 v63, v166, v165, v11
    v_alignbit_b32 v64, v169, v168, v11
    v_alignbit_b32 v65, v170, v169, v11
    v_alignbit_b32 v66, v171, v170, v11
    v_alignbit_b32 v67, v172, v171, v11
    v_alignbit_b32 v68, v175, v174, v11
    v_alignbit_b32 v69, v176, v175, v11
    v_alignbit_b32 v70, v177, v176, v11
    v_alignbit_b32 v71, v178, v177, v11
    v_alignbit_b32 v72, v181, v180, v11
    v_alignbit_b32 v73, v182, v181, v11
    v_alignbit_b32 v74, v183, v182, v11
    v_alignbit_b32 v75, v184, v183, v11
    v_alignbit_b32 v76, v187, v186, v11
    v_alignbit_b32 v77, v188, v187, v11
    v_alignbit_b32 v78, v189, v188, v11
    v_alignbit_b32 v79, v190, v189, v11
    s_waitcnt lgkmcnt(0)
    ds_read2_b32 v[144:145], v201 offset0:32 offset1:33
    ds_read2_b32 v[146:147], v201 offset0:34 offset1:35
    ds_read_b32 v148, v201 offset:144
    ds_read2_b32 v[150:151], v202 offset0:32 offset1:33
    ds_read2_b32 v[152:153], v202 offset0:34 offset1:35
    ds_read_b32 v154, v202 offset:144
    ds_read2_b32 v[156:157], v203 offset0:32 offset1:33
    ds_read2_b32 v[158:159], v203 offset0:34 offset1:35
    ds_read_b32 v160, v203 offset:144
    ds_read2_b32 v[162:163], v204 offset0:32 offset1:33
    ds_read2_b32 v[164:165], v204 offset0:34 offset1:35
    ds_read_b32 v166, v204 offset:144
    ds_read2_b32 v[168:169], v205 offset0:32 offset1:33
    ds_read2_b32 v[170:171], v205 offset0:34 offset1:35
    ds_read_b32 v172, v205 offset:144
    ds_read2_b32 v[174:175], v206 offset0:32 offset1:33
    ds_read2_b32 v[176:177], v206 offset0:34 offset1:35
    ds_read_b32 v178, v206 offset:144
    ds_read2_b32 v[180:181], v207 offset0:32 offset1:33
    ds_read2_b32 v[182:183], v207 offset0:34 offset1:35
    ds_read_b32 v184, v207 offset:144
    ds_read2_b32 v[186:187], v208 offset0:32 offset1:33
    ds_read2_b32 v[188:189], v208 offset0:34 offset1:35
    ds_read_b32 v190, v208 offset:144
    ds_read_b128 v[80:83], v14 offset:3712
    ds_read_b128 v[84:87], v14 offset:3200
    ds_read_b128 v[88:91], v14 offset:2688
    ds_read_b128 v[92:95], v14 offset:2176
    ds_read_b128 v[96:99], v14 offset:1664
    ds_read_b128 v[100:103], v14 offset:1152
    ds_read_b128 v[104:107], v14 offset:640
    ds_read_b128 v[108:111], v14 offset:128
    v_mfma_f32_16x16x32_bf16 v[16:19], v[48:51], v[112:115], v[16:19]
    v_mfma_f32_16x16x32_bf16 v[20:23], v[48:51], v[116:119], v[20:23]
    v_mfma_f32_16x16x32_bf16 v[20:23], v[52:55], v[112:115], v[20:23]
    v_mfma_f32_16x16x32_bf16 v[24:27], v[48:51], v[120:123], v[24:27]
    v_mfma_f32_16x16x32_bf16 v[24:27], v[52:55], v[116:119], v[24:27]
    v_mfma_f32_16x16x32_bf16 v[24:27], v[56:59], v[112:115], v[24:27]
    v_mfma_f32_16x16x32_bf16 v[28:31], v[48:51], v[124:127], v[28:31]
    v_mfma_f32_16x16x32_bf16 v[28:31], v[52:55], v[120:123], v[28:31]
    v_mfma_f32_16x16x32_bf16 v[28:31], v[56:59], v[116:119], v[28:31]
    v_mfma_f32_16x16x32_bf16 v[28:31], v[60:63], v[112:115], v[28:31]
    v_mfma_f32_16x16x32_bf16 v[32:35], v[48:51], v[128:131], v[32:35]
    v_mfma_f32_16x16x32_bf16 v[32:35], v[52:55], v[124:127], v[32:35]
    v_mfma_f32_16x16x32_bf16 v[32:35], v[56:59], v[120:123], v[32:35]
    v_mfma_f32_16x16x32_bf16 v[32:35], v[60:63], v[116:119], v[32:35]
    v_mfma_f32_16x16x32_bf16 v[32:35], v[64:67], v[112:115], v[32:35]
    v_mfma_f32_16x16x32_bf16 v[36:39], v[48:51], v[132:135], v[36:39]
    v_mfma_f32_16x16x32_bf16 v[36:39], v[52:55], v[128:131], v[36:39]
    v_mfma_f32_16x16x32_bf16 v[36:39], v[56:59], v[124:127], v[36:39]
    v_mfma_f32_16x16x32_bf16 v[36:39], v[60:63], v[120:123], v[36:39]
    v_mfma_f32_16x16x32_bf16 v[36:39], v[64:67], v[116:119], v[36:39]
    v_mfma_f32_16x16x32_bf16 v[36:39], v[68:71], v[112:115], v[36:39]
    v_mfma_f32_16x16x32_bf16 v[40:43], v[48:51], v[136:139], v[40:43]
    v_mfma_f32_16x16x32_bf16 v[40:43], v[52:55], v[132:135], v[40:43]
    v_mfma_f32_16x16x32_bf16 v[40:43], v[56:59], v[128:131], v[40:43]
    v_mfma_f32_16x16x32_bf16 v[40:43], v[60:63], v[124:127], v[40:43]
    v_mfma_f32_16x16x32_bf16 v[40:43], v[64:67], v[120:123], v[40:43]
    v_mfma_f32_16x16x32_bf16 v[40:43], v[68:71], v[116:119], v[40:43]
    v_mfma_f32_16x16x32_bf16 v[40:43], v[72:75], v[112:115], v[40:43]
    v_mfma_f32_16x16x32_bf16 v[44:47], v[48:51], v[140:143], v[44:47]
    v_mfma_f32_16x16x32_bf16 v[44:47], v[52:55], v[136:139], v[44:47]
    v_mfma_f32_16x16x32_bf16 v[44:47], v[56:59], v[132:135], v[44:47]
    v_mfma_f32_16x16x32_bf16 v[44:47], v[60:63], v[128:131], v[44:47]
    v_mfma_f32_16x16x32_bf16 v[44:47], v[64:67], v[124:127], v[44:47]
    v_mfma_f32_16x16x32_bf16 v[44:47], v[68:71], v[120:123], v[44:47]
    v_mfma_f32_16x16x32_bf16 v[44:47], v[72:75], v[116:119], v[44:47]
    v_mfma_f32_16x16x32_bf16 v[44:47], v[76:79], v[112:115], v[44:47]
    s_waitcnt lgkmcnt(0)
    v_alignbit_b32 v48, v145, v144, v11
    v_alignbit_b32 v49, v146, v145, v11
    v_alignbit_b32 v50, v147, v146, v11
    v_alignbit_b32 v51, v148, v147, v11
    v_alignbit_b32 v52, v151, v150, v11
    v_alignbit_b32 v53, v152, v151, v11
    v_alignbit_b32 v54, v153, v152, v11
    v_alignbit_b32 v55, v154, v153, v11
    v_alignbit_b32 v56, v157, v156, v11
    v_alignbit_b32 v57, v158, v157, v11
    v_alignbit_b32 v58, v159, v158, v11
    v_alignbit_b32 v59, v160, v159, v11
    v_alignbit_b32 v60, v163, v162, v11
    v_alignbit_b32 v61, v164, v163, v11
    v_alignbit_b32 v62, v165, v164, v11
    v_alignbit_b32 v63, v166, v165, v11
    v_alignbit_b32 v64, v169, v168, v11
    v_alignbit_b32 v65, v170, v169, v11
    v_alignbit_b32 v66, v171, v170, v11
    v_alignbit_b32 v67, v172, v171, v11
    v_alignbit_b32 v68, v175, v174, v11
    v_alignbit_b32 v69, v176, v175, v11
    v_alignbit_b32 v70, v177, v176, v11
    v_alignbit_b32 v71, v178, v177, v11
    v_alignbit_b32 v72, v181, v180, v11
    v_alignbit_b32 v73, v182, v181, v11
    v_alignbit_b32 v74, v183, v182, v11
    v_alignbit_b32 v75, v184, v183, v11
    v_alignbit_b32 v76, v187, v186, v11
    v_alignbit_b32 v77, v188, v187, v11
    v_alignbit_b32 v78, v189, v188, v11
    v_alignbit_b32 v79, v190, v189, v11
    s_waitcnt lgkmcnt(0)
    ds_read2_b32 v[144:145], v201 offset0:48 offset1:49
    ds_read2_b32 v[146:147], v201 offset0:50 offset1:51
    ds_read_b32 v148, v201 offset:208
    ds_read2_b32 v[150:151], v202 offset0:48 offset1:49
    ds_read2_b32 v[152:153], v202 offset0:50 offset1:51
    ds_read_b32 v154, v202 offset:208
    ds_read2_b32 v[156:157], v203 offset0:48 offset1:49
    ds_read2_b32 v[158:159], v203 offset0:50 offset1:51
    ds_read_b32 v160, v203 offset:208
    ds_read2_b32 v[162:163], v204 offset0:48 offset1:49
    ds_read2_b32 v[164:165], v204 offset0:50 offset1:51
    ds_read_b32 v166, v204 offset:208
    ds_read2_b32 v[168:169], v205 offset0:48 offset1:49
    ds_read2_b32 v[170:171], v205 offset0:50 offset1:51
    ds_read_b32 v172, v205 offset:208
    ds_read2_b32 v[174:175], v206 offset0:48 offset1:49
    ds_read2_b32 v[176:177], v206 offset0:50 offset1:51
    ds_read_b32 v178, v206 offset:208
    ds_read2_b32 v[180:181], v207 offset0:48 offset1:49
    ds_read2_b32 v[182:183], v207 offset0:50 offset1:51
    ds_read_b32 v184, v207 offset:208
    ds_read2_b32 v[186:187], v208 offset0:48 offset1:49
    ds_read2_b32 v[188:189], v208 offset0:50 offset1:51
    ds_read_b32 v190, v208 offset:208
    ds_read_b128 v[112:115], v14 offset:3776
    ds_read_b128 v[116:119], v14 offset:3264
    ds_read_b128 v[120:123], v14 offset:2752
    ds_read_b128 v[124:127], v14 offset:2240
    ds_read_b128 v[128:131], v14 offset:1728
    ds_read_b128 v[132:135], v14 offset:1216
    ds_read_b128 v[136:139], v14 offset:704
    ds_read_b128 v[140:143], v14 offset:192
    v_mfma_f32_16x16x32_bf16 v[16:19], v[48:51], v[80:83], v[16:19]
    v_mfma_f32_16x16x32_bf16 v[20:23], v[48:51], v[84:87], v[20:23]
    v_mfma_f32_16x16x32_bf16 v[20:23], v[52:55], v[80:83], v[20:23]
    v_mfma_f32_16x16x32_bf16 v[24:27], v[48:51], v[88:91], v[24:27]
    v_mfma_f32_16x16x32_bf16 v[24:27], v[52:55], v[84:87], v[24:27]
    v_mfma_f32_16x16x32_bf16 v[24:27], v[56:59], v[80:83], v[24:27]
    v_mfma_f32_16x16x32_bf16 v[28:31], v[48:51], v[92:95], v[28:31]
    v_mfma_f32_16x16x32_bf16 v[28:31], v[52:55], v[88:91], v[28:31]
    v_mfma_f32_16x16x32_bf16 v[28:31], v[56:59], v[84:87], v[28:31]
    v_mfma_f32_16x16x32_bf16 v[28:31], v[60:63], v[80:83], v[28:31]
    v_mfma_f32_16x16x32_bf16 v[32:35], v[48:51], v[96:99], v[32:35]
    v_mfma_f32_16x16x32_bf16 v[32:35], v[52:55], v[92:95], v[32:35]
    v_mfma_f32_16x16x32_bf16 v[32:35], v[56:59], v[88:91], v[32:35]
    v_mfma_f32_16x16x32_bf16 v[32:35], v[60:63], v[84:87], v[32:35]
    v_mfma_f32_16x16x32_bf16 v[32:35], v[64:67], v[80:83], v[32:35]
    v_mfma_f32_16x16x32_bf16 v[36:39], v[48:51], v[100:103], v[36:39]
    v_mfma_f32_16x16x32_bf16 v[36:39], v[52:55], v[96:99], v[36:39]
    v_mfma_f32_16x16x32_bf16 v[36:39], v[56:59], v[92:95], v[36:39]
    v_mfma_f32_16x16x32_bf16 v[36:39], v[60:63], v[88:91], v[36:39]
    v_mfma_f32_16x16x32_bf16 v[36:39], v[64:67], v[84:87], v[36:39]
    v_mfma_f32_16x16x32_bf16 v[36:39], v[68:71], v[80:83], v[36:39]
    v_mfma_f32_16x16x32_bf16 v[40:43], v[48:51], v[104:107], v[40:43]
    v_mfma_f32_16x16x32_bf16 v[40:43], v[52:55], v[100:103], v[40:43]
    v_mfma_f32_16x16x32_bf16 v[40:43], v[56:59], v[96:99], v[40:43]
    v_mfma_f32_16x16x32_bf16 v[40:43], v[60:63], v[92:95], v[40:43]
    v_mfma_f32_16x16x32_bf16 v[40:43], v[64:67], v[88:91], v[40:43]
    v_mfma_f32_16x16x32_bf16 v[40:43], v[68:71], v[84:87], v[40:43]
    v_mfma_f32_16x16x32_bf16 v[40:43], v[72:75], v[80:83], v[40:43]
    v_mfma_f32_16x16x32_bf16 v[44:47], v[48:51], v[108:111], v[44:47]
    v_mfma_f32_16x16x32_bf16 v[44:47], v[52:55], v[104:107], v[44:47]
    v_mfma_f32_16x16x32_bf16 v[44:47], v[56:59], v[100:103], v[44:47]
    v_mfma_f32_16x16x32_bf16 v[44:47], v[60:63], v[96:99], v[44:47]
    v_mfma_f32_16x16x32_bf16 v[44:47], v[64:67], v[92:95], v[44:47]
    v_mfma_f32_16x16x32_bf16 v[44:47], v[68:71], v[88:91], v[44:47]
    v_mfma_f32_16x16x32_bf16 v[44:47], v[72:75], v[84:87], v[44:47]
    v_mfma_f32_16x16x32_bf16 v[44:47], v[76:79], v[80:83], v[44:47]
    s_waitcnt lgkmcnt(0)
    v_alignbit_b32 v48, v145, v144, v11
    v_alignbit_b32 v49, v146, v145, v11
    v_alignbit_b32 v50, v147, v146, v11
    v_alignbit_b32 v51, v148, v147, v11
    v_alignbit_b32 v52, v151, v150, v11
    v_alignbit_b32 v53, v152, v151, v11
    v_alignbit_b32 v54, v153, v152, v11
    v_alignbit_b32 v55, v154, v153, v11
    v_alignbit_b32 v56, v157, v156, v11
    v_alignbit_b32 v57, v158, v157, v11
    v_alignbit_b32 v58, v159, v158, v11
    v_alignbit_b32 v59, v160, v159, v11
    v_alignbit_b32 v60, v163, v162, v11
    v_alignbit_b32 v61, v164, v163, v11
    v_alignbit_b32 v62, v165, v164, v11
    v_alignbit_b32 v63, v166, v165, v11
    v_alignbit_b32 v64, v169, v168, v11
    v_alignbit_b32 v65, v170, v169, v11
    v_alignbit_b32 v66, v171, v170, v11
    v_alignbit_b32 v67, v172, v171, v11
    v_alignbit_b32 v68, v175, v174, v11
    v_alignbit_b32 v69, v176, v175, v11
    v_alignbit_b32 v70, v177, v176, v11
    v_alignbit_b32 v71, v178, v177, v11
    v_alignbit_b32 v72, v181, v180, v11
    v_alignbit_b32 v73, v182, v181, v11
    v_alignbit_b32 v74, v183, v182, v11
    v_alignbit_b32 v75, v184, v183, v11
    v_alignbit_b32 v76, v187, v186, v11
    v_alignbit_b32 v77, v188, v187, v11
    v_alignbit_b32 v78, v189, v188, v11
    v_alignbit_b32 v79, v190, v189, v11
    s_waitcnt lgkmcnt(0)
    ds_read2_b32 v[144:145], v201 offset0:64 offset1:65
    ds_read2_b32 v[146:147], v201 offset0:66 offset1:67
    ds_read_b32 v148, v201 offset:272
    ds_read2_b32 v[150:151], v202 offset0:64 offset1:65
    ds_read2_b32 v[152:153], v202 offset0:66 offset1:67
    ds_read_b32 v154, v202 offset:272
    ds_read2_b32 v[156:157], v203 offset0:64 offset1:65
    ds_read2_b32 v[158:159], v203 offset0:66 offset1:67
    ds_read_b32 v160, v203 offset:272
    ds_read2_b32 v[162:163], v204 offset0:64 offset1:65
    ds_read2_b32 v[164:165], v204 offset0:66 offset1:67
    ds_read_b32 v166, v204 offset:272
    ds_read2_b32 v[168:169], v205 offset0:64 offset1:65
    ds_read2_b32 v[170:171], v205 offset0:66 offset1:67
    ds_read_b32 v172, v205 offset:272
    ds_read2_b32 v[174:175], v206 offset0:64 offset1:65
    ds_read2_b32 v[176:177], v206 offset0:66 offset1:67
    ds_read_b32 v178, v206 offset:272
    ds_read2_b32 v[180:181], v207 offset0:64 offset1:65
    ds_read2_b32 v[182:183], v207 offset0:66 offset1:67
    ds_read_b32 v184, v207 offset:272
    ds_read2_b32 v[186:187], v208 offset0:64 offset1:65
    ds_read2_b32 v[188:189], v208 offset0:66 offset1:67
    ds_read_b32 v190, v208 offset:272
    ds_read_b128 v[80:83], v14 offset:3840
    ds_read_b128 v[84:87], v14 offset:3328
    ds_read_b128 v[88:91], v14 offset:2816
    ds_read_b128 v[92:95], v14 offset:2304
    ds_read_b128 v[96:99], v14 offset:1792
    ds_read_b128 v[100:103], v14 offset:1280
    ds_read_b128 v[104:107], v14 offset:768
    ds_read_b128 v[108:111], v14 offset:256
    v_mfma_f32_16x16x32_bf16 v[16:19], v[48:51], v[112:115], v[16:19]
    v_mfma_f32_16x16x32_bf16 v[20:23], v[48:51], v[116:119], v[20:23]
    v_mfma_f32_16x16x32_bf16 v[20:23], v[52:55], v[112:115], v[20:23]
    v_mfma_f32_16x16x32_bf16 v[24:27], v[48:51], v[120:123], v[24:27]
    v_mfma_f32_16x16x32_bf16 v[24:27], v[52:55], v[116:119], v[24:27]
    v_mfma_f32_16x16x32_bf16 v[24:27], v[56:59], v[112:115], v[24:27]
    v_mfma_f32_16x16x32_bf16 v[28:31], v[48:51], v[124:127], v[28:31]
    v_mfma_f32_16x16x32_bf16 v[28:31], v[52:55], v[120:123], v[28:31]
    v_mfma_f32_16x16x32_bf16 v[28:31], v[56:59], v[116:119], v[28:31]
    v_mfma_f32_16x16x32_bf16 v[28:31], v[60:63], v[112:115], v[28:31]
    v_mfma_f32_16x16x32_bf16 v[32:35], v[48:51], v[128:131], v[32:35]
    v_mfma_f32_16x16x32_bf16 v[32:35], v[52:55], v[124:127], v[32:35]
    v_mfma_f32_16x16x32_bf16 v[32:35], v[56:59], v[120:123], v[32:35]
    v_mfma_f32_16x16x32_bf16 v[32:35], v[60:63], v[116:119], v[32:35]
    v_mfma_f32_16x16x32_bf16 v[32:35], v[64:67], v[112:115], v[32:35]
    v_mfma_f32_16x16x32_bf16 v[36:39], v[48:51], v[132:135], v[36:39]
    v_mfma_f32_16x16x32_bf16 v[36:39], v[52:55], v[128:131], v[36:39]
    v_mfma_f32_16x16x32_bf16 v[36:39], v[56:59], v[124:127], v[36:39]
    v_mfma_f32_16x16x32_bf16 v[36:39], v[60:63], v[120:123], v[36:39]
    v_mfma_f32_16x16x32_bf16 v[36:39], v[64:67], v[116:119], v[36:39]
    v_mfma_f32_16x16x32_bf16 v[36:39], v[68:71], v[112:115], v[36:39]
    v_mfma_f32_16x16x32_bf16 v[40:43], v[48:51], v[136:139], v[40:43]
    v_mfma_f32_16x16x32_bf16 v[40:43], v[52:55], v[132:135], v[40:43]
    v_mfma_f32_16x16x32_bf16 v[40:43], v[56:59], v[128:131], v[40:43]
    v_mfma_f32_16x16x32_bf16 v[40:43], v[60:63], v[124:127], v[40:43]
    v_mfma_f32_16x16x32_bf16 v[40:43], v[64:67], v[120:123], v[40:43]
    v_mfma_f32_16x16x32_bf16 v[40:43], v[68:71], v[116:119], v[40:43]
    v_mfma_f32_16x16x32_bf16 v[40:43], v[72:75], v[112:115], v[40:43]
    v_mfma_f32_16x16x32_bf16 v[44:47], v[48:51], v[140:143], v[44:47]
    v_mfma_f32_16x16x32_bf16 v[44:47], v[52:55], v[136:139], v[44:47]
    v_mfma_f32_16x16x32_bf16 v[44:47], v[56:59], v[132:135], v[44:47]
    v_mfma_f32_16x16x32_bf16 v[44:47], v[60:63], v[128:131], v[44:47]
    v_mfma_f32_16x16x32_bf16 v[44:47], v[64:67], v[124:127], v[44:47]
    v_mfma_f32_16x16x32_bf16 v[44:47], v[68:71], v[120:123], v[44:47]
    v_mfma_f32_16x16x32_bf16 v[44:47], v[72:75], v[116:119], v[44:47]
    v_mfma_f32_16x16x32_bf16 v[44:47], v[76:79], v[112:115], v[44:47]
    s_waitcnt lgkmcnt(0)
    v_alignbit_b32 v48, v145, v144, v11
    v_alignbit_b32 v49, v146, v145, v11
    v_alignbit_b32 v50, v147, v146, v11
    v_alignbit_b32 v51, v148, v147, v11
    v_alignbit_b32 v52, v151, v150, v11
    v_alignbit_b32 v53, v152, v151, v11
    v_alignbit_b32 v54, v153, v152, v11
    v_alignbit_b32 v55, v154, v153, v11
    v_alignbit_b32 v56, v157, v156, v11
    v_alignbit_b32 v57, v158, v157, v11
    v_alignbit_b32 v58, v159, v158, v11
    v_alignbit_b32 v59, v160, v159, v11
    v_alignbit_b32 v60, v163, v162, v11
    v_alignbit_b32 v61, v164, v163, v11
    v_alignbit_b32 v62, v165, v164, v11
    v_alignbit_b32 v63, v166, v165, v11
    v_alignbit_b32 v64, v169, v168, v11
    v_alignbit_b32 v65, v170, v169, v11
    v_alignbit_b32 v66, v171, v170, v11
    v_alignbit_b32 v67, v172, v171, v11
    v_alignbit_b32 v68, v175, v174, v11
    v_alignbit_b32 v69, v176, v175, v11
    v_alignbit_b32 v70, v177, v176, v11
    v_alignbit_b32 v71, v178, v177, v11
    v_alignbit_b32 v72, v181, v180, v11
    v_alignbit_b32 v73, v182, v181, v11
    v_alignbit_b32 v74, v183, v182, v11
    v_alignbit_b32 v75, v184, v183, v11
    v_alignbit_b32 v76, v187, v186, v11
    v_alignbit_b32 v77, v188, v187, v11
    v_alignbit_b32 v78, v189, v188, v11
    v_alignbit_b32 v79, v190, v189, v11
    s_waitcnt lgkmcnt(0)
    ds_read2_b32 v[144:145], v201 offset0:80 offset1:81
    ds_read2_b32 v[146:147], v201 offset0:82 offset1:83
    ds_read_b32 v148, v201 offset:336
    ds_read2_b32 v[150:151], v202 offset0:80 offset1:81
    ds_read2_b32 v[152:153], v202 offset0:82 offset1:83
    ds_read_b32 v154, v202 offset:336
    ds_read2_b32 v[156:157], v203 offset0:80 offset1:81
    ds_read2_b32 v[158:159], v203 offset0:82 offset1:83
    ds_read_b32 v160, v203 offset:336
    ds_read2_b32 v[162:163], v204 offset0:80 offset1:81
    ds_read2_b32 v[164:165], v204 offset0:82 offset1:83
    ds_read_b32 v166, v204 offset:336
    ds_read2_b32 v[168:169], v205 offset0:80 offset1:81
    ds_read2_b32 v[170:171], v205 offset0:82 offset1:83
    ds_read_b32 v172, v205 offset:336
    ds_read2_b32 v[174:175], v206 offset0:80 offset1:81
    ds_read2_b32 v[176:177], v206 offset0:82 offset1:83
    ds_read_b32 v178, v206 offset:336
    ds_read2_b32 v[180:181], v207 offset0:80 offset1:81
    ds_read2_b32 v[182:183], v207 offset0:82 offset1:83
    ds_read_b32 v184, v207 offset:336
    ds_read2_b32 v[186:187], v208 offset0:80 offset1:81
    ds_read2_b32 v[188:189], v208 offset0:82 offset1:83
    ds_read_b32 v190, v208 offset:336
    ds_read_b128 v[112:115], v14 offset:3904
    ds_read_b128 v[116:119], v14 offset:3392
    ds_read_b128 v[120:123], v14 offset:2880
    ds_read_b128 v[124:127], v14 offset:2368
    ds_read_b128 v[128:131], v14 offset:1856
    ds_read_b128 v[132:135], v14 offset:1344
    ds_read_b128 v[136:139], v14 offset:832
    ds_read_b128 v[140:143], v14 offset:320
    v_mfma_f32_16x16x32_bf16 v[16:19], v[48:51], v[80:83], v[16:19]
    v_mfma_f32_16x16x32_bf16 v[20:23], v[48:51], v[84:87], v[20:23]
    v_mfma_f32_16x16x32_bf16 v[20:23], v[52:55], v[80:83], v[20:23]
    v_mfma_f32_16x16x32_bf16 v[24:27], v[48:51], v[88:91], v[24:27]
    v_mfma_f32_16x16x32_bf16 v[24:27], v[52:55], v[84:87], v[24:27]
    v_mfma_f32_16x16x32_bf16 v[24:27], v[56:59], v[80:83], v[24:27]
    v_mfma_f32_16x16x32_bf16 v[28:31], v[48:51], v[92:95], v[28:31]
    v_mfma_f32_16x16x32_bf16 v[28:31], v[52:55], v[88:91], v[28:31]
    v_mfma_f32_16x16x32_bf16 v[28:31], v[56:59], v[84:87], v[28:31]
    v_mfma_f32_16x16x32_bf16 v[28:31], v[60:63], v[80:83], v[28:31]
    v_mfma_f32_16x16x32_bf16 v[32:35], v[48:51], v[96:99], v[32:35]
    v_mfma_f32_16x16x32_bf16 v[32:35], v[52:55], v[92:95], v[32:35]
    v_mfma_f32_16x16x32_bf16 v[32:35], v[56:59], v[88:91], v[32:35]
    v_mfma_f32_16x16x32_bf16 v[32:35], v[60:63], v[84:87], v[32:35]
    v_mfma_f32_16x16x32_bf16 v[32:35], v[64:67], v[80:83], v[32:35]
    v_mfma_f32_16x16x32_bf16 v[36:39], v[48:51], v[100:103], v[36:39]
    v_mfma_f32_16x16x32_bf16 v[36:39], v[52:55], v[96:99], v[36:39]
    v_mfma_f32_16x16x32_bf16 v[36:39], v[56:59], v[92:95], v[36:39]
    v_mfma_f32_16x16x32_bf16 v[36:39], v[60:63], v[88:91], v[36:39]
    v_mfma_f32_16x16x32_bf16 v[36:39], v[64:67], v[84:87], v[36:39]
    v_mfma_f32_16x16x32_bf16 v[36:39], v[68:71], v[80:83], v[36:39]
    v_mfma_f32_16x16x32_bf16 v[40:43], v[48:51], v[104:107], v[40:43]
    v_mfma_f32_16x16x32_bf16 v[40:43], v[52:55], v[100:103], v[40:43]
    v_mfma_f32_16x16x32_bf16 v[40:43], v[56:59], v[96:99], v[40:43]
    v_mfma_f32_16x16x32_bf16 v[40:43], v[60:63], v[92:95], v[40:43]
    v_mfma_f32_16x16x32_bf16 v[40:43], v[64:67], v[88:91], v[40:43]
    v_mfma_f32_16x16x32_bf16 v[40:43], v[68:71], v[84:87], v[40:43]
    v_mfma_f32_16x16x32_bf16 v[40:43], v[72:75], v[80:83], v[40:43]
    v_mfma_f32_16x16x32_bf16 v[44:47], v[48:51], v[108:111], v[44:47]
    v_mfma_f32_16x16x32_bf16 v[44:47], v[52:55], v[104:107], v[44:47]
    v_mfma_f32_16x16x32_bf16 v[44:47], v[56:59], v[100:103], v[44:47]
    v_mfma_f32_16x16x32_bf16 v[44:47], v[60:63], v[96:99], v[44:47]
    v_mfma_f32_16x16x32_bf16 v[44:47], v[64:67], v[92:95], v[44:47]
    v_mfma_f32_16x16x32_bf16 v[44:47], v[68:71], v[88:91], v[44:47]
    v_mfma_f32_16x16x32_bf16 v[44:47], v[72:75], v[84:87], v[44:47]
    v_mfma_f32_16x16x32_bf16 v[44:47], v[76:79], v[80:83], v[44:47]
    s_waitcnt lgkmcnt(0)
    v_alignbit_b32 v48, v145, v144, v11
    v_alignbit_b32 v49, v146, v145, v11
    v_alignbit_b32 v50, v147, v146, v11
    v_alignbit_b32 v51, v148, v147, v11
    v_alignbit_b32 v52, v151, v150, v11
    v_alignbit_b32 v53, v152, v151, v11
    v_alignbit_b32 v54, v153, v152, v11
    v_alignbit_b32 v55, v154, v153, v11
    v_alignbit_b32 v56, v157, v156, v11
    v_alignbit_b32 v57, v158, v157, v11
    v_alignbit_b32 v58, v159, v158, v11
    v_alignbit_b32 v59, v160, v159, v11
    v_alignbit_b32 v60, v163, v162, v11
    v_alignbit_b32 v61, v164, v163, v11
    v_alignbit_b32 v62, v165, v164, v11
    v_alignbit_b32 v63, v166, v165, v11
    v_alignbit_b32 v64, v169, v168, v11
    v_alignbit_b32 v65, v170, v169, v11
    v_alignbit_b32 v66, v171, v170, v11
    v_alignbit_b32 v67, v172, v171, v11
    v_alignbit_b32 v68, v175, v174, v11
    v_alignbit_b32 v69, v176, v175, v11
    v_alignbit_b32 v70, v177, v176, v11
    v_alignbit_b32 v71, v178, v177, v11
    v_alignbit_b32 v72, v181, v180, v11
    v_alignbit_b32 v73, v182, v181, v11
    v_alignbit_b32 v74, v183, v182, v11
    v_alignbit_b32 v75, v184, v183, v11
    v_alignbit_b32 v76, v187, v186, v11
    v_alignbit_b32 v77, v188, v187, v11
    v_alignbit_b32 v78, v189, v188, v11
    v_alignbit_b32 v79, v190, v189, v11
    s_waitcnt lgkmcnt(0)
    ds_read2_b32 v[144:145], v201 offset0:96 offset1:97
    ds_read2_b32 v[146:147], v201 offset0:98 offset1:99
    ds_read_b32 v148, v201 offset:400
    ds_read2_b32 v[150:151], v202 offset0:96 offset1:97
    ds_read2_b32 v[152:153], v202 offset0:98 offset1:99
    ds_read_b32 v154, v202 offset:400
    ds_read2_b32 v[156:157], v203 offset0:96 offset1:97
    ds_read2_b32 v[158:159], v203 offset0:98 offset1:99
    ds_read_b32 v160, v203 offset:400
    ds_read2_b32 v[162:163], v204 offset0:96 offset1:97
    ds_read2_b32 v[164:165], v204 offset0:98 offset1:99
    ds_read_b32 v166, v204 offset:400
    ds_read2_b32 v[168:169], v205 offset0:96 offset1:97
    ds_read2_b32 v[170:171], v205 offset0:98 offset1:99
    ds_read_b32 v172, v205 offset:400
    ds_read2_b32 v[174:175], v206 offset0:96 offset1:97
    ds_read2_b32 v[176:177], v206 offset0:98 offset1:99
    ds_read_b32 v178, v206 offset:400
    ds_read2_b32 v[180:181], v207 offset0:96 offset1:97
    ds_read2_b32 v[182:183], v207 offset0:98 offset1:99
    ds_read_b32 v184, v207 offset:400
    ds_read2_b32 v[186:187], v208 offset0:96 offset1:97
    ds_read2_b32 v[188:189], v208 offset0:98 offset1:99
    ds_read_b32 v190, v208 offset:400
    ds_read_b128 v[80:83], v14 offset:3968
    ds_read_b128 v[84:87], v14 offset:3456
    ds_read_b128 v[88:91], v14 offset:2944
    ds_read_b128 v[92:95], v14 offset:2432
    ds_read_b128 v[96:99], v14 offset:1920
    ds_read_b128 v[100:103], v14 offset:1408
    ds_read_b128 v[104:107], v14 offset:896
    ds_read_b128 v[108:111], v14 offset:384
    v_mfma_f32_16x16x32_bf16 v[16:19], v[48:51], v[112:115], v[16:19]
    v_mfma_f32_16x16x32_bf16 v[20:23], v[48:51], v[116:119], v[20:23]
    v_mfma_f32_16x16x32_bf16 v[20:23], v[52:55], v[112:115], v[20:23]
    v_mfma_f32_16x16x32_bf16 v[24:27], v[48:51], v[120:123], v[24:27]
    v_mfma_f32_16x16x32_bf16 v[24:27], v[52:55], v[116:119], v[24:27]
    v_mfma_f32_16x16x32_bf16 v[24:27], v[56:59], v[112:115], v[24:27]
    v_mfma_f32_16x16x32_bf16 v[28:31], v[48:51], v[124:127], v[28:31]
    v_mfma_f32_16x16x32_bf16 v[28:31], v[52:55], v[120:123], v[28:31]
    v_mfma_f32_16x16x32_bf16 v[28:31], v[56:59], v[116:119], v[28:31]
    v_mfma_f32_16x16x32_bf16 v[28:31], v[60:63], v[112:115], v[28:31]
    v_mfma_f32_16x16x32_bf16 v[32:35], v[48:51], v[128:131], v[32:35]
    v_mfma_f32_16x16x32_bf16 v[32:35], v[52:55], v[124:127], v[32:35]
    v_mfma_f32_16x16x32_bf16 v[32:35], v[56:59], v[120:123], v[32:35]
    v_mfma_f32_16x16x32_bf16 v[32:35], v[60:63], v[116:119], v[32:35]
    v_mfma_f32_16x16x32_bf16 v[32:35], v[64:67], v[112:115], v[32:35]
    v_mfma_f32_16x16x32_bf16 v[36:39], v[48:51], v[132:135], v[36:39]
    v_mfma_f32_16x16x32_bf16 v[36:39], v[52:55], v[128:131], v[36:39]
    v_mfma_f32_16x16x32_bf16 v[36:39], v[56:59], v[124:127], v[36:39]
    v_mfma_f32_16x16x32_bf16 v[36:39], v[60:63], v[120:123], v[36:39]
    v_mfma_f32_16x16x32_bf16 v[36:39], v[64:67], v[116:119], v[36:39]
    v_mfma_f32_16x16x32_bf16 v[36:39], v[68:71], v[112:115], v[36:39]
    v_mfma_f32_16x16x32_bf16 v[40:43], v[48:51], v[136:139], v[40:43]
    v_mfma_f32_16x16x32_bf16 v[40:43], v[52:55], v[132:135], v[40:43]
    v_mfma_f32_16x16x32_bf16 v[40:43], v[56:59], v[128:131], v[40:43]
    v_mfma_f32_16x16x32_bf16 v[40:43], v[60:63], v[124:127], v[40:43]
    v_mfma_f32_16x16x32_bf16 v[40:43], v[64:67], v[120:123], v[40:43]
    v_mfma_f32_16x16x32_bf16 v[40:43], v[68:71], v[116:119], v[40:43]
    v_mfma_f32_16x16x32_bf16 v[40:43], v[72:75], v[112:115], v[40:43]
    v_mfma_f32_16x16x32_bf16 v[44:47], v[48:51], v[140:143], v[44:47]
    v_mfma_f32_16x16x32_bf16 v[44:47], v[52:55], v[136:139], v[44:47]
    v_mfma_f32_16x16x32_bf16 v[44:47], v[56:59], v[132:135], v[44:47]
    v_mfma_f32_16x16x32_bf16 v[44:47], v[60:63], v[128:131], v[44:47]
    v_mfma_f32_16x16x32_bf16 v[44:47], v[64:67], v[124:127], v[44:47]
    v_mfma_f32_16x16x32_bf16 v[44:47], v[68:71], v[120:123], v[44:47]
    v_mfma_f32_16x16x32_bf16 v[44:47], v[72:75], v[116:119], v[44:47]
    v_mfma_f32_16x16x32_bf16 v[44:47], v[76:79], v[112:115], v[44:47]
    s_waitcnt lgkmcnt(0)
    v_alignbit_b32 v48, v145, v144, v11
    v_alignbit_b32 v49, v146, v145, v11
    v_alignbit_b32 v50, v147, v146, v11
    v_alignbit_b32 v51, v148, v147, v11
    v_alignbit_b32 v52, v151, v150, v11
    v_alignbit_b32 v53, v152, v151, v11
    v_alignbit_b32 v54, v153, v152, v11
    v_alignbit_b32 v55, v154, v153, v11
    v_alignbit_b32 v56, v157, v156, v11
    v_alignbit_b32 v57, v158, v157, v11
    v_alignbit_b32 v58, v159, v158, v11
    v_alignbit_b32 v59, v160, v159, v11
    v_alignbit_b32 v60, v163, v162, v11
    v_alignbit_b32 v61, v164, v163, v11
    v_alignbit_b32 v62, v165, v164, v11
    v_alignbit_b32 v63, v166, v165, v11
    v_alignbit_b32 v64, v169, v168, v11
    v_alignbit_b32 v65, v170, v169, v11
    v_alignbit_b32 v66, v171, v170, v11
    v_alignbit_b32 v67, v172, v171, v11
    v_alignbit_b32 v68, v175, v174, v11
    v_alignbit_b32 v69, v176, v175, v11
    v_alignbit_b32 v70, v177, v176, v11
    v_alignbit_b32 v71, v178, v177, v11
    v_alignbit_b32 v72, v181, v180, v11
    v_alignbit_b32 v73, v182, v181, v11
    v_alignbit_b32 v74, v183, v182, v11
    v_alignbit_b32 v75, v184, v183, v11
    v_alignbit_b32 v76, v187, v186, v11
    v_alignbit_b32 v77, v188, v187, v11
    v_alignbit_b32 v78, v189, v188, v11
    v_alignbit_b32 v79, v190, v189, v11
    s_waitcnt lgkmcnt(0)
    ds_read2_b32 v[144:145], v201 offset0:112 offset1:113
    ds_read2_b32 v[146:147], v201 offset0:114 offset1:115
    ds_read_b32 v148, v201 offset:464
    ds_read2_b32 v[150:151], v202 offset0:112 offset1:113
    ds_read2_b32 v[152:153], v202 offset0:114 offset1:115
    ds_read_b32 v154, v202 offset:464
    ds_read2_b32 v[156:157], v203 offset0:112 offset1:113
    ds_read2_b32 v[158:159], v203 offset0:114 offset1:115
    ds_read_b32 v160, v203 offset:464
    ds_read2_b32 v[162:163], v204 offset0:112 offset1:113
    ds_read2_b32 v[164:165], v204 offset0:114 offset1:115
    ds_read_b32 v166, v204 offset:464
    ds_read2_b32 v[168:169], v205 offset0:112 offset1:113
    ds_read2_b32 v[170:171], v205 offset0:114 offset1:115
    ds_read_b32 v172, v205 offset:464
    ds_read2_b32 v[174:175], v206 offset0:112 offset1:113
    ds_read2_b32 v[176:177], v206 offset0:114 offset1:115
    ds_read_b32 v178, v206 offset:464
    ds_read2_b32 v[180:181], v207 offset0:112 offset1:113
    ds_read2_b32 v[182:183], v207 offset0:114 offset1:115
    ds_read_b32 v184, v207 offset:464
    ds_read2_b32 v[186:187], v208 offset0:112 offset1:113
    ds_read2_b32 v[188:189], v208 offset0:114 offset1:115
    ds_read_b32 v190, v208 offset:464
    ds_read_b128 v[112:115], v14 offset:4032
    ds_read_b128 v[116:119], v14 offset:3520
    ds_read_b128 v[120:123], v14 offset:3008
    ds_read_b128 v[124:127], v14 offset:2496
    ds_read_b128 v[128:131], v14 offset:1984
    ds_read_b128 v[132:135], v14 offset:1472
    ds_read_b128 v[136:139], v14 offset:960
    ds_read_b128 v[140:143], v14 offset:448
    v_mfma_f32_16x16x32_bf16 v[16:19], v[48:51], v[80:83], v[16:19]
    v_mfma_f32_16x16x32_bf16 v[20:23], v[48:51], v[84:87], v[20:23]
    v_mfma_f32_16x16x32_bf16 v[20:23], v[52:55], v[80:83], v[20:23]
    v_mfma_f32_16x16x32_bf16 v[24:27], v[48:51], v[88:91], v[24:27]
    v_mfma_f32_16x16x32_bf16 v[24:27], v[52:55], v[84:87], v[24:27]
    v_mfma_f32_16x16x32_bf16 v[24:27], v[56:59], v[80:83], v[24:27]
    v_mfma_f32_16x16x32_bf16 v[28:31], v[48:51], v[92:95], v[28:31]
    v_mfma_f32_16x16x32_bf16 v[28:31], v[52:55], v[88:91], v[28:31]
    v_mfma_f32_16x16x32_bf16 v[28:31], v[56:59], v[84:87], v[28:31]
    v_mfma_f32_16x16x32_bf16 v[28:31], v[60:63], v[80:83], v[28:31]
    v_mfma_f32_16x16x32_bf16 v[32:35], v[48:51], v[96:99], v[32:35]
    v_mfma_f32_16x16x32_bf16 v[32:35], v[52:55], v[92:95], v[32:35]
    v_mfma_f32_16x16x32_bf16 v[32:35], v[56:59], v[88:91], v[32:35]
    v_mfma_f32_16x16x32_bf16 v[32:35], v[60:63], v[84:87], v[32:35]
    v_mfma_f32_16x16x32_bf16 v[32:35], v[64:67], v[80:83], v[32:35]
    v_mfma_f32_16x16x32_bf16 v[36:39], v[48:51], v[100:103], v[36:39]
    v_mfma_f32_16x16x32_bf16 v[36:39], v[52:55], v[96:99], v[36:39]
    v_mfma_f32_16x16x32_bf16 v[36:39], v[56:59], v[92:95], v[36:39]
    v_mfma_f32_16x16x32_bf16 v[36:39], v[60:63], v[88:91], v[36:39]
    v_mfma_f32_16x16x32_bf16 v[36:39], v[64:67], v[84:87], v[36:39]
    v_mfma_f32_16x16x32_bf16 v[36:39], v[68:71], v[80:83], v[36:39]
    v_mfma_f32_16x16x32_bf16 v[40:43], v[48:51], v[104:107], v[40:43]
    v_mfma_f32_16x16x32_bf16 v[40:43], v[52:55], v[100:103], v[40:43]
    v_mfma_f32_16x16x32_bf16 v[40:43], v[56:59], v[96:99], v[40:43]
    v_mfma_f32_16x16x32_bf16 v[40:43], v[60:63], v[92:95], v[40:43]
    v_mfma_f32_16x16x32_bf16 v[40:43], v[64:67], v[88:91], v[40:43]
    v_mfma_f32_16x16x32_bf16 v[40:43], v[68:71], v[84:87], v[40:43]
    v_mfma_f32_16x16x32_bf16 v[40:43], v[72:75], v[80:83], v[40:43]
    v_mfma_f32_16x16x32_bf16 v[44:47], v[48:51], v[108:111], v[44:47]
    v_mfma_f32_16x16x32_bf16 v[44:47], v[52:55], v[104:107], v[44:47]
    v_mfma_f32_16x16x32_bf16 v[44:47], v[56:59], v[100:103], v[44:47]
    v_mfma_f32_16x16x32_bf16 v[44:47], v[60:63], v[96:99], v[44:47]
    v_mfma_f32_16x16x32_bf16 v[44:47], v[64:67], v[92:95], v[44:47]
    v_mfma_f32_16x16x32_bf16 v[44:47], v[68:71], v[88:91], v[44:47]
    v_mfma_f32_16x16x32_bf16 v[44:47], v[72:75], v[84:87], v[44:47]
    v_mfma_f32_16x16x32_bf16 v[44:47], v[76:79], v[80:83], v[44:47]
    s_waitcnt lgkmcnt(0)
    v_alignbit_b32 v48, v145, v144, v11
    v_alignbit_b32 v49, v146, v145, v11
    v_alignbit_b32 v50, v147, v146, v11
    v_alignbit_b32 v51, v148, v147, v11
    v_alignbit_b32 v52, v151, v150, v11
    v_alignbit_b32 v53, v152, v151, v11
    v_alignbit_b32 v54, v153, v152, v11
    v_alignbit_b32 v55, v154, v153, v11
    v_alignbit_b32 v56, v157, v156, v11
    v_alignbit_b32 v57, v158, v157, v11
    v_alignbit_b32 v58, v159, v158, v11
    v_alignbit_b32 v59, v160, v159, v11
    v_alignbit_b32 v60, v163, v162, v11
    v_alignbit_b32 v61, v164, v163, v11
    v_alignbit_b32 v62, v165, v164, v11
    v_alignbit_b32 v63, v166, v165, v11
    v_alignbit_b32 v64, v169, v168, v11
    v_alignbit_b32 v65, v170, v169, v11
    v_alignbit_b32 v66, v171, v170, v11
    v_alignbit_b32 v67, v172, v171, v11
    v_alignbit_b32 v68, v175, v174, v11
    v_alignbit_b32 v69, v176, v175, v11
    v_alignbit_b32 v70, v177, v176, v11
    v_alignbit_b32 v71, v178, v177, v11
    v_alignbit_b32 v72, v181, v180, v11
    v_alignbit_b32 v73, v182, v181, v11
    v_alignbit_b32 v74, v183, v182, v11
    v_alignbit_b32 v75, v184, v183, v11
    v_alignbit_b32 v76, v187, v186, v11
    v_alignbit_b32 v77, v188, v187, v11
    v_alignbit_b32 v78, v189, v188, v11
    v_alignbit_b32 v79, v190, v189, v11
    s_waitcnt lgkmcnt(0)
    s_nop 1
    v_mfma_f32_16x16x32_bf16 v[16:19], v[48:51], v[112:115], v[16:19]
    v_mfma_f32_16x16x32_bf16 v[20:23], v[48:51], v[116:119], v[20:23]
    v_mfma_f32_16x16x32_bf16 v[20:23], v[52:55], v[112:115], v[20:23]
    v_mfma_f32_16x16x32_bf16 v[24:27], v[48:51], v[120:123], v[24:27]
    v_mfma_f32_16x16x32_bf16 v[24:27], v[52:55], v[116:119], v[24:27]
    v_mfma_f32_16x16x32_bf16 v[24:27], v[56:59], v[112:115], v[24:27]
    v_mfma_f32_16x16x32_bf16 v[28:31], v[48:51], v[124:127], v[28:31]
    v_mfma_f32_16x16x32_bf16 v[28:31], v[52:55], v[120:123], v[28:31]
    v_mfma_f32_16x16x32_bf16 v[28:31], v[56:59], v[116:119], v[28:31]
    v_mfma_f32_16x16x32_bf16 v[28:31], v[60:63], v[112:115], v[28:31]
    v_mfma_f32_16x16x32_bf16 v[32:35], v[48:51], v[128:131], v[32:35]
    v_mfma_f32_16x16x32_bf16 v[32:35], v[52:55], v[124:127], v[32:35]
    v_mfma_f32_16x16x32_bf16 v[32:35], v[56:59], v[120:123], v[32:35]
    v_mfma_f32_16x16x32_bf16 v[32:35], v[60:63], v[116:119], v[32:35]
    v_mfma_f32_16x16x32_bf16 v[32:35], v[64:67], v[112:115], v[32:35]
    v_mfma_f32_16x16x32_bf16 v[36:39], v[48:51], v[132:135], v[36:39]
    v_mfma_f32_16x16x32_bf16 v[36:39], v[52:55], v[128:131], v[36:39]
    v_mfma_f32_16x16x32_bf16 v[36:39], v[56:59], v[124:127], v[36:39]
    v_mfma_f32_16x16x32_bf16 v[36:39], v[60:63], v[120:123], v[36:39]
    v_mfma_f32_16x16x32_bf16 v[36:39], v[64:67], v[116:119], v[36:39]
    v_mfma_f32_16x16x32_bf16 v[36:39], v[68:71], v[112:115], v[36:39]
    v_mfma_f32_16x16x32_bf16 v[40:43], v[48:51], v[136:139], v[40:43]
    v_mfma_f32_16x16x32_bf16 v[40:43], v[52:55], v[132:135], v[40:43]
    v_mfma_f32_16x16x32_bf16 v[40:43], v[56:59], v[128:131], v[40:43]
    v_mfma_f32_16x16x32_bf16 v[40:43], v[60:63], v[124:127], v[40:43]
    v_mfma_f32_16x16x32_bf16 v[40:43], v[64:67], v[120:123], v[40:43]
    v_mfma_f32_16x16x32_bf16 v[40:43], v[68:71], v[116:119], v[40:43]
    v_mfma_f32_16x16x32_bf16 v[40:43], v[72:75], v[112:115], v[40:43]
    v_mfma_f32_16x16x32_bf16 v[44:47], v[48:51], v[140:143], v[44:47]
    v_mfma_f32_16x16x32_bf16 v[44:47], v[52:55], v[136:139], v[44:47]
    v_mfma_f32_16x16x32_bf16 v[44:47], v[56:59], v[132:135], v[44:47]
    v_mfma_f32_16x16x32_bf16 v[44:47], v[60:63], v[128:131], v[44:47]
    v_mfma_f32_16x16x32_bf16 v[44:47], v[64:67], v[124:127], v[44:47]
    v_mfma_f32_16x16x32_bf16 v[44:47], v[68:71], v[120:123], v[44:47]
    v_mfma_f32_16x16x32_bf16 v[44:47], v[72:75], v[116:119], v[44:47]
    v_mfma_f32_16x16x32_bf16 v[44:47], v[76:79], v[112:115], v[44:47]
    s_nop 7
    s_nop 1
    v_lshlrev_b32 v200, 16, v200
    v_lshlrev_b32 v6, 4, v6
    v_lshl_add_u32 v6, v7, 2, v6
    v_lshlrev_b32 v8, 1, v6
    v_sub_u32 v8, 4088, v8
    v_add_u32 v8, s32, v8
    v_add_u32 v8, -3584, v8
    v_lshlrev_b32 v9, 3, v6
    v_lshl_add_u32 v9, v1, 1, v9
    v_add_u32 v9, 18432, v9
    ds_read_b64 v[198:199], v8 offset:3584
    s_waitcnt lgkmcnt(0)
    v_and_b32 v192, 0xffff0000, v199
    v_lshlrev_b32 v193, 16, v199
    v_and_b32 v194, 0xffff0000, v198
    v_lshlrev_b32 v195, 16, v198
    v_mul_f32 v192, v192, v200
    v_mul_f32 v193, v193, v200
    v_mul_f32 v194, v194, v200
    v_mul_f32 v195, v195, v200
    v_cvt_pk_bf16_f32 v196, v192, v193
    v_lshlrev_b32 v192, 16, v196
    v_and_b32 v193, 0xffff0000, v196
    v_cvt_pk_bf16_f32 v196, v194, v195
    v_lshlrev_b32 v194, 16, v196
    v_and_b32 v195, 0xffff0000, v196
    v_cvt_pk_bf16_f32 v196, v16, v17
    v_lshlrev_b32 v16, 16, v196
    v_and_b32 v17, 0xffff0000, v196
    v_cvt_pk_bf16_f32 v196, v18, v19
    v_lshlrev_b32 v18, 16, v196
    v_and_b32 v19, 0xffff0000, v196
    v_add_f32 v192, v192, v16
    v_add_f32 v193, v193, v17
    v_add_f32 v194, v194, v18
    v_add_f32 v195, v195, v19
    v_cvt_pk_bf16_f32 v196, v192, v193
    v_cvt_pk_bf16_f32 v197, v194, v195
    ds_write_b16 v9, v196 offset:0
    ds_write_b16_d16_hi v9, v196 offset:8
    ds_write_b16 v9, v197 offset:16
    ds_write_b16_d16_hi v9, v197 offset:24
    ds_read_b64 v[198:199], v8 offset:3072
    s_waitcnt lgkmcnt(0)
    v_and_b32 v192, 0xffff0000, v199
    v_lshlrev_b32 v193, 16, v199
    v_and_b32 v194, 0xffff0000, v198
    v_lshlrev_b32 v195, 16, v198
    v_mul_f32 v192, v192, v200
    v_mul_f32 v193, v193, v200
    v_mul_f32 v194, v194, v200
    v_mul_f32 v195, v195, v200
    v_cvt_pk_bf16_f32 v196, v192, v193
    v_lshlrev_b32 v192, 16, v196
    v_and_b32 v193, 0xffff0000, v196
    v_cvt_pk_bf16_f32 v196, v194, v195
    v_lshlrev_b32 v194, 16, v196
    v_and_b32 v195, 0xffff0000, v196
    v_cvt_pk_bf16_f32 v196, v20, v21
    v_lshlrev_b32 v20, 16, v196
    v_and_b32 v21, 0xffff0000, v196
    v_cvt_pk_bf16_f32 v196, v22, v23
    v_lshlrev_b32 v22, 16, v196
    v_and_b32 v23, 0xffff0000, v196
    v_add_f32 v192, v192, v20
    v_add_f32 v193, v193, v21
    v_add_f32 v194, v194, v22
    v_add_f32 v195, v195, v23
    v_cvt_pk_bf16_f32 v196, v192, v193
    v_cvt_pk_bf16_f32 v197, v194, v195
    ds_write_b16 v9, v196 offset:2048
    ds_write_b16_d16_hi v9, v196 offset:2056
    ds_write_b16 v9, v197 offset:2064
    ds_write_b16_d16_hi v9, v197 offset:2072
    ds_read_b64 v[198:199], v8 offset:2560
    s_waitcnt lgkmcnt(0)
    v_and_b32 v192, 0xffff0000, v199
    v_lshlrev_b32 v193, 16, v199
    v_and_b32 v194, 0xffff0000, v198
    v_lshlrev_b32 v195, 16, v198
    v_mul_f32 v192, v192, v200
    v_mul_f32 v193, v193, v200
    v_mul_f32 v194, v194, v200
    v_mul_f32 v195, v195, v200
    v_cvt_pk_bf16_f32 v196, v192, v193
    v_lshlrev_b32 v192, 16, v196
    v_and_b32 v193, 0xffff0000, v196
    v_cvt_pk_bf16_f32 v196, v194, v195
    v_lshlrev_b32 v194, 16, v196
    v_and_b32 v195, 0xffff0000, v196
    v_cvt_pk_bf16_f32 v196, v24, v25
    v_lshlrev_b32 v24, 16, v196
    v_and_b32 v25, 0xffff0000, v196
    v_cvt_pk_bf16_f32 v196, v26, v27
    v_lshlrev_b32 v26, 16, v196
    v_and_b32 v27, 0xffff0000, v196
    v_add_f32 v192, v192, v24
    v_add_f32 v193, v193, v25
    v_add_f32 v194, v194, v26
    v_add_f32 v195, v195, v27
    v_cvt_pk_bf16_f32 v196, v192, v193
    v_cvt_pk_bf16_f32 v197, v194, v195
    ds_write_b16 v9, v196 offset:4096
    ds_write_b16_d16_hi v9, v196 offset:4104
    ds_write_b16 v9, v197 offset:4112
    ds_write_b16_d16_hi v9, v197 offset:4120
    ds_read_b64 v[198:199], v8 offset:2048
    s_waitcnt lgkmcnt(0)
    v_and_b32 v192, 0xffff0000, v199
    v_lshlrev_b32 v193, 16, v199
    v_and_b32 v194, 0xffff0000, v198
    v_lshlrev_b32 v195, 16, v198
    v_mul_f32 v192, v192, v200
    v_mul_f32 v193, v193, v200
    v_mul_f32 v194, v194, v200
    v_mul_f32 v195, v195, v200
    v_cvt_pk_bf16_f32 v196, v192, v193
    v_lshlrev_b32 v192, 16, v196
    v_and_b32 v193, 0xffff0000, v196
    v_cvt_pk_bf16_f32 v196, v194, v195
    v_lshlrev_b32 v194, 16, v196
    v_and_b32 v195, 0xffff0000, v196
    v_cvt_pk_bf16_f32 v196, v28, v29
    v_lshlrev_b32 v28, 16, v196
    v_and_b32 v29, 0xffff0000, v196
    v_cvt_pk_bf16_f32 v196, v30, v31
    v_lshlrev_b32 v30, 16, v196
    v_and_b32 v31, 0xffff0000, v196
    v_add_f32 v192, v192, v28
    v_add_f32 v193, v193, v29
    v_add_f32 v194, v194, v30
    v_add_f32 v195, v195, v31
    v_cvt_pk_bf16_f32 v196, v192, v193
    v_cvt_pk_bf16_f32 v197, v194, v195
    ds_write_b16 v9, v196 offset:6144
    ds_write_b16_d16_hi v9, v196 offset:6152
    ds_write_b16 v9, v197 offset:6160
    ds_write_b16_d16_hi v9, v197 offset:6168
    ds_read_b64 v[198:199], v8 offset:1536
    s_waitcnt lgkmcnt(0)
    v_and_b32 v192, 0xffff0000, v199
    v_lshlrev_b32 v193, 16, v199
    v_and_b32 v194, 0xffff0000, v198
    v_lshlrev_b32 v195, 16, v198
    v_mul_f32 v192, v192, v200
    v_mul_f32 v193, v193, v200
    v_mul_f32 v194, v194, v200
    v_mul_f32 v195, v195, v200
    v_cvt_pk_bf16_f32 v196, v192, v193
    v_lshlrev_b32 v192, 16, v196
    v_and_b32 v193, 0xffff0000, v196
    v_cvt_pk_bf16_f32 v196, v194, v195
    v_lshlrev_b32 v194, 16, v196
    v_and_b32 v195, 0xffff0000, v196
    v_cvt_pk_bf16_f32 v196, v32, v33
    v_lshlrev_b32 v32, 16, v196
    v_and_b32 v33, 0xffff0000, v196
    v_cvt_pk_bf16_f32 v196, v34, v35
    v_lshlrev_b32 v34, 16, v196
    v_and_b32 v35, 0xffff0000, v196
    v_add_f32 v192, v192, v32
    v_add_f32 v193, v193, v33
    v_add_f32 v194, v194, v34
    v_add_f32 v195, v195, v35
    v_cvt_pk_bf16_f32 v196, v192, v193
    v_cvt_pk_bf16_f32 v197, v194, v195
    ds_write_b16 v9, v196 offset:8192
    ds_write_b16_d16_hi v9, v196 offset:8200
    ds_write_b16 v9, v197 offset:8208
    ds_write_b16_d16_hi v9, v197 offset:8216
    ds_read_b64 v[198:199], v8 offset:1024
    s_waitcnt lgkmcnt(0)
    v_and_b32 v192, 0xffff0000, v199
    v_lshlrev_b32 v193, 16, v199
    v_and_b32 v194, 0xffff0000, v198
    v_lshlrev_b32 v195, 16, v198
    v_mul_f32 v192, v192, v200
    v_mul_f32 v193, v193, v200
    v_mul_f32 v194, v194, v200
    v_mul_f32 v195, v195, v200
    v_cvt_pk_bf16_f32 v196, v192, v193
    v_lshlrev_b32 v192, 16, v196
    v_and_b32 v193, 0xffff0000, v196
    v_cvt_pk_bf16_f32 v196, v194, v195
    v_lshlrev_b32 v194, 16, v196
    v_and_b32 v195, 0xffff0000, v196
    v_cvt_pk_bf16_f32 v196, v36, v37
    v_lshlrev_b32 v36, 16, v196
    v_and_b32 v37, 0xffff0000, v196
    v_cvt_pk_bf16_f32 v196, v38, v39
    v_lshlrev_b32 v38, 16, v196
    v_and_b32 v39, 0xffff0000, v196
    v_add_f32 v192, v192, v36
    v_add_f32 v193, v193, v37
    v_add_f32 v194, v194, v38
    v_add_f32 v195, v195, v39
    v_cvt_pk_bf16_f32 v196, v192, v193
    v_cvt_pk_bf16_f32 v197, v194, v195
    ds_write_b16 v9, v196 offset:10240
    ds_write_b16_d16_hi v9, v196 offset:10248
    ds_write_b16 v9, v197 offset:10256
    ds_write_b16_d16_hi v9, v197 offset:10264
    ds_read_b64 v[198:199], v8 offset:512
    s_waitcnt lgkmcnt(0)
    v_and_b32 v192, 0xffff0000, v199
    v_lshlrev_b32 v193, 16, v199
    v_and_b32 v194, 0xffff0000, v198
    v_lshlrev_b32 v195, 16, v198
    v_mul_f32 v192, v192, v200
    v_mul_f32 v193, v193, v200
    v_mul_f32 v194, v194, v200
    v_mul_f32 v195, v195, v200
    v_cvt_pk_bf16_f32 v196, v192, v193
    v_lshlrev_b32 v192, 16, v196
    v_and_b32 v193, 0xffff0000, v196
    v_cvt_pk_bf16_f32 v196, v194, v195
    v_lshlrev_b32 v194, 16, v196
    v_and_b32 v195, 0xffff0000, v196
    v_cvt_pk_bf16_f32 v196, v40, v41
    v_lshlrev_b32 v40, 16, v196
    v_and_b32 v41, 0xffff0000, v196
    v_cvt_pk_bf16_f32 v196, v42, v43
    v_lshlrev_b32 v42, 16, v196
    v_and_b32 v43, 0xffff0000, v196
    v_add_f32 v192, v192, v40
    v_add_f32 v193, v193, v41
    v_add_f32 v194, v194, v42
    v_add_f32 v195, v195, v43
    v_cvt_pk_bf16_f32 v196, v192, v193
    v_cvt_pk_bf16_f32 v197, v194, v195
    ds_write_b16 v9, v196 offset:12288
    ds_write_b16_d16_hi v9, v196 offset:12296
    ds_write_b16 v9, v197 offset:12304
    ds_write_b16_d16_hi v9, v197 offset:12312
    ds_read_b64 v[198:199], v8 offset:0
    s_waitcnt lgkmcnt(0)
    v_and_b32 v192, 0xffff0000, v199
    v_lshlrev_b32 v193, 16, v199
    v_and_b32 v194, 0xffff0000, v198
    v_lshlrev_b32 v195, 16, v198
    v_mul_f32 v192, v192, v200
    v_mul_f32 v193, v193, v200
    v_mul_f32 v194, v194, v200
    v_mul_f32 v195, v195, v200
    v_cvt_pk_bf16_f32 v196, v192, v193
    v_lshlrev_b32 v192, 16, v196
    v_and_b32 v193, 0xffff0000, v196
    v_cvt_pk_bf16_f32 v196, v194, v195
    v_lshlrev_b32 v194, 16, v196
    v_and_b32 v195, 0xffff0000, v196
    v_cvt_pk_bf16_f32 v196, v44, v45
    v_lshlrev_b32 v44, 16, v196
    v_and_b32 v45, 0xffff0000, v196
    v_cvt_pk_bf16_f32 v196, v46, v47
    v_lshlrev_b32 v46, 16, v196
    v_and_b32 v47, 0xffff0000, v196
    v_add_f32 v192, v192, v44
    v_add_f32 v193, v193, v45
    v_add_f32 v194, v194, v46
    v_add_f32 v195, v195, v47
    v_cvt_pk_bf16_f32 v196, v192, v193
    v_cvt_pk_bf16_f32 v197, v194, v195
    ds_write_b16 v9, v196 offset:14336
    ds_write_b16_d16_hi v9, v196 offset:14344
    ds_write_b16 v9, v197 offset:14352
    ds_write_b16_d16_hi v9, v197 offset:14360
    s_waitcnt lgkmcnt(0)
    s_barrier
    v_lshlrev_b32 v3, 3, v0
    v_lshlrev_b32 v4, 10, v0
    s_lshl_b32 s30, s2, 3
    v_add_u32 v4, s30, v4
    ds_read_b64 v[10:11], v3 offset:18432
    ds_read_b64 v[12:13], v3 offset:20480
    ds_read_b64 v[14:15], v3 offset:22528
    ds_read_b64 v[16:17], v3 offset:24576
    ds_read_b64 v[18:19], v3 offset:26624
    ds_read_b64 v[20:21], v3 offset:28672
    ds_read_b64 v[22:23], v3 offset:30720
    ds_read_b64 v[24:25], v3 offset:32768
    s_waitcnt lgkmcnt(0)
    v_add_u32 v5, 0, v4
    buffer_store_dwordx2 v[10:11], v5, s[24:27], 0 offen
    v_add_u32 v5, 262144, v4
    buffer_store_dwordx2 v[12:13], v5, s[24:27], 0 offen
    v_add_u32 v5, 524288, v4
    buffer_store_dwordx2 v[14:15], v5, s[24:27], 0 offen
    v_add_u32 v5, 786432, v4
    buffer_store_dwordx2 v[16:17], v5, s[24:27], 0 offen
    v_add_u32 v5, 1048576, v4
    buffer_store_dwordx2 v[18:19], v5, s[24:27], 0 offen
    v_add_u32 v5, 1310720, v4
    buffer_store_dwordx2 v[20:21], v5, s[24:27], 0 offen
    v_add_u32 v5, 1572864, v4
    buffer_store_dwordx2 v[22:23], v5, s[24:27], 0 offen
    v_add_u32 v5, 1835008, v4
    buffer_store_dwordx2 v[24:25], v5, s[24:27], 0 offen
cv_end:
    s_endpgm
rp_entry:
    s_sub_u32 s2, s2, 128
    s_cmp_ge_u32 s2, 672
    s_cbranch_scc1 rp_end
    s_load_dwordx4 s[4:7], s[0:1], 56
    s_load_dwordx2 s[8:9], s[0:1], 72
    s_load_dwordx2 s[10:11], s[0:1], 96
    s_waitcnt lgkmcnt(0)
    v_lshrrev_b32 v1, 3, v0
    v_and_b32 v2, 7, v0
    s_cmp_ge_u32 s2, 448
    s_cbranch_scc1 rp_d
    s_cmp_ge_u32 s2, 224
    s_cbranch_scc1 rp_u
    s_mul_i32 s28, s2, 2341
    s_lshr_b32 s28, s28, 16
    s_mul_i32 s29, s28, 28
    s_sub_u32 s29, s2, s29
    s_add_u32 s12, s4, 0
    s_addc_u32 s13, s5, 0
    s_mov_b32 s14, 1835008
    s_mov_b32 s15, 0x20000
    s_add_u32 s24, s10, 8388608
    s_addc_u32 s25, s11, 0
    s_mov_b32 s26, 2097152
    s_mov_b32 s27, 0x20000
    s_mul_i32 s30, s28, 229376
    s_lshl_b32 s31, s29, 7
    s_add_u32 s30, s30, s31
    v_mul_u32_u24 v3, 3584, v1
    v_lshl_add_u32 v3, v2, 4, v3
    v_add_u32 v3, s30, v3
    buffer_load_dwordx4 v[10:13], v3, s[12:15], 0 offen
    v_add_u32 v4, 114688, v3
    buffer_load_dwordx4 v[14:17], v4, s[12:15], 0 offen
    v_mul_u32_u24 v5, 1152, v2
    v_lshl_add_u32 v5, v1, 1, v5
    s_waitcnt vmcnt(0)
    ds_write_b16 v5, v10 offset:0
    ds_write_b16_d16_hi v5, v10 offset:144
    ds_write_b16 v5, v11 offset:288
    ds_write_b16_d16_hi v5, v11 offset:432
    ds_write_b16 v5, v12 offset:576
    ds_write_b16_d16_hi v5, v12 offset:720
    ds_write_b16 v5, v13 offset:864
    ds_write_b16_d16_hi v5, v13 offset:1008
    ds_write_b16 v5, v14 offset:64
    ds_write_b16_d16_hi v5, v14 offset:208
    ds_write_b16 v5, v15 offset:352
    ds_write_b16_d16_hi v5, v15 offset:496
    ds_write_b16 v5, v16 offset:640
    ds_write_b16_d16_hi v5, v16 offset:784
    ds_write_b16 v5, v17 offset:928
    ds_write_b16_d16_hi v5, v17 offset:1072
    s_waitcnt lgkmcnt(0)
    s_barrier
    v_and_b32 v6, 63, v0
    v_lshrrev_b32 v7, 6, v0
    v_and_b32 v8, 15, v6
    v_lshrrev_b32 v9, 4, v6
    v_lshl_add_u32 v8, v7, 4, v8
    v_mul_u32_u24 v8, 144, v8
    v_lshl_add_u32 v8, v9, 4, v8
    ds_read_b128 v[10:13], v8
    ds_read_b128 v[14:17], v8 offset:64
    s_lshl_b32 s31, s29, 2
    s_mul_i32 s31, s31, 16
    s_lshl_b32 s30, s28, 1
    s_add_u32 s30, s30, s31
    s_lshl_b32 s30, s30, 10
    v_mul_u32_u24 v9, 16384, v7
    v_lshl_add_u32 v9, v6, 4, v9
    v_add_u32 v9, s30, v9
    s_waitcnt lgkmcnt(0)
    buffer_store_dwordx4 v[10:13], v9, s[24:27], 0 offen
    buffer_store_dwordx4 v[14:17], v9, s[24:27], 0 offen offset:1024
    s_branch rp_end
rp_u:
    s_sub_u32 s3, s2, 224
    s_mul_i32 s28, s3, 2341
    s_lshr_b32 s28, s28, 16
    s_mul_i32 s29, s28, 28
    s_sub_u32 s29, s3, s29
    s_add_u32 s12, s6, 0
    s_addc_u32 s13, s7, 0
    s_mov_b32 s14, 1835008
    s_mov_b32 s15, 0x20000
    s_add_u32 s24, s10, 10485760
    s_addc_u32 s25, s11, 0
    s_mov_b32 s26, 2097152
    s_mov_b32 s27, 0x20000
    s_mul_i32 s30, s28, 229376
    s_lshl_b32 s31, s29, 7
    s_add_u32 s30, s30, s31
    v_mul_u32_u24 v3, 3584, v1
    v_lshl_add_u32 v3, v2, 4, v3
    v_add_u32 v3, s30, v3
    buffer_load_dwordx4 v[10:13], v3, s[12:15], 0 offen
    v_add_u32 v4, 114688, v3
    buffer_load_dwordx4 v[14:17], v4, s[12:15], 0 offen
    v_mul_u32_u24 v5, 1152, v2
    v_lshl_add_u32 v5, v1, 1, v5
    s_waitcnt vmcnt(0)
    ds_write_b16 v5, v10 offset:0
    ds_write_b16_d16_hi v5, v10 offset:144
    ds_write_b16 v5, v11 offset:288
    ds_write_b16_d16_hi v5, v11 offset:432
    ds_write_b16 v5, v12 offset:576
    ds_write_b16_d16_hi v5, v12 offset:720
    ds_write_b16 v5, v13 offset:864
    ds_write_b16_d16_hi v5, v13 offset:1008
    ds_write_b16 v5, v14 offset:64
    ds_write_b16_d16_hi v5, v14 offset:208
    ds_write_b16 v5, v15 offset:352
    ds_write_b16_d16_hi v5, v15 offset:496
    ds_write_b16 v5, v16 offset:640
    ds_write_b16_d16_hi v5, v16 offset:784
    ds_write_b16 v5, v17 offset:928
    ds_write_b16_d16_hi v5, v17 offset:1072
    s_waitcnt lgkmcnt(0)
    s_barrier
    v_and_b32 v6, 63, v0
    v_lshrrev_b32 v7, 6, v0
    v_and_b32 v8, 15, v6
    v_lshrrev_b32 v9, 4, v6
    v_lshl_add_u32 v8, v7, 4, v8
    v_mul_u32_u24 v8, 144, v8
    v_lshl_add_u32 v8, v9, 4, v8
    ds_read_b128 v[10:13], v8
    ds_read_b128 v[14:17], v8 offset:64
    s_lshl_b32 s31, s29, 2
    s_mul_i32 s31, s31, 16
    s_lshl_b32 s30, s28, 1
    s_add_u32 s30, s30, s31
    s_lshl_b32 s30, s30, 10
    v_mul_u32_u24 v9, 16384, v7
    v_lshl_add_u32 v9, v6, 4, v9
    v_add_u32 v9, s30, v9
    s_waitcnt lgkmcnt(0)
    buffer_store_dwordx4 v[10:13], v9, s[24:27], 0 offen
    buffer_store_dwordx4 v[14:17], v9, s[24:27], 0 offen offset:1024
    s_branch rp_end
rp_d:
    s_sub_u32 s3, s2, 448
    s_lshr_b32 s28, s3, 3
    s_and_b32 s29, s3, 7
    s_add_u32 s12, s8, 0
    s_addc_u32 s13, s9, 0
    s_mov_b32 s14, 1835008
    s_mov_b32 s15, 0x20000
    s_add_u32 s24, s10, 12582912
    s_addc_u32 s25, s11, 0
    s_mov_b32 s26, 2097152
    s_mov_b32 s27, 0x20000
    s_mul_i32 s30, s28, 65536
    s_lshl_b32 s31, s29, 7
    s_add_u32 s30, s30, s31
    v_mul_u32_u24 v3, 1024, v1
    v_lshl_add_u32 v3, v2, 4, v3
    v_add_u32 v3, s30, v3
    buffer_load_dwordx4 v[10:13], v3, s[12:15], 0 offen
    v_add_u32 v4, 32768, v3
    buffer_load_dwordx4 v[14:17], v4, s[12:15], 0 offen
    v_mul_u32_u24 v5, 1152, v2
    v_lshl_add_u32 v5, v1, 1, v5
    s_waitcnt vmcnt(0)
    ds_write_b16 v5, v10 offset:0
    ds_write_b16_d16_hi v5, v10 offset:144
    ds_write_b16 v5, v11 offset:288
    ds_write_b16_d16_hi v5, v11 offset:432
    ds_write_b16 v5, v12 offset:576
    ds_write_b16_d16_hi v5, v12 offset:720
    ds_write_b16 v5, v13 offset:864
    ds_write_b16_d16_hi v5, v13 offset:1008
    ds_write_b16 v5, v14 offset:64
    ds_write_b16_d16_hi v5, v14 offset:208
    ds_write_b16 v5, v15 offset:352
    ds_write_b16_d16_hi v5, v15 offset:496
    ds_write_b16 v5, v16 offset:640
    ds_write_b16_d16_hi v5, v16 offset:784
    ds_write_b16 v5, v17 offset:928
    ds_write_b16_d16_hi v5, v17 offset:1072
    s_waitcnt lgkmcnt(0)
    s_barrier
    v_and_b32 v6, 63, v0
    v_lshrrev_b32 v7, 6, v0
    v_and_b32 v8, 15, v6
    v_lshrrev_b32 v9, 4, v6
    v_lshl_add_u32 v8, v7, 4, v8
    v_mul_u32_u24 v8, 144, v8
    v_lshl_add_u32 v8, v9, 4, v8
    ds_read_b128 v[10:13], v8
    ds_read_b128 v[14:17], v8 offset:64
    s_lshl_b32 s31, s29, 2
    s_mul_i32 s31, s31, 56
    s_lshl_b32 s30, s28, 1
    s_add_u32 s30, s30, s31
    s_lshl_b32 s30, s30, 10
    v_mul_u32_u24 v9, 57344, v7
    v_lshl_add_u32 v9, v6, 4, v9
    v_add_u32 v9, s30, v9
    s_waitcnt lgkmcnt(0)
    buffer_store_dwordx4 v[10:13], v9, s[24:27], 0 offen
    buffer_store_dwordx4 v[14:17], v9, s[24:27], 0 offen offset:1024
    s_branch rp_end
rp_end:
    s_endpgm
.globl ln_kernel
.p2align 8
.type ln_kernel,@function
ln_kernel:
    s_cmp_ge_u32 s2, 128
    s_cbranch_scc1 ln_end
    s_load_dwordx2 s[4:5], s[0:1], 0
    s_load_dwordx2 s[10:11], s[0:1], 96
    s_waitcnt lgkmcnt(0)
    s_add_u32 s12, s4, 0
    s_addc_u32 s13, s5, 0
    s_mov_b32 s14, 2097152
    s_mov_b32 s15, 0x20000
    s_add_u32 s16, s10, 2097152
    s_addc_u32 s17, s11, 0
    s_mov_b32 s18, 2097152
    s_mov_b32 s19, 0x20000
    s_add_u32 s20, s10, 4194304
    s_addc_u32 s21, s11, 0
    s_mov_b32 s22, 2097152
    s_mov_b32 s23, 0x20000
    s_add_u32 s24, s10, 6291456
    s_addc_u32 s25, s11, 0
    s_mov_b32 s26, 2097152
    s_mov_b32 s27, 0x20000
    v_lshrrev_b32 v1, 4, v0
    v_and_b32 v2, 15, v0
    s_lshl_b32 s28, s2, 14
    v_lshlrev_b32 v3, 10, v1
    v_lshl_add_u32 v3, v2, 4, v3
    v_add_u32 v3, s28, v3
    buffer_load_dwordx4 v[4:7], v3, s[12:15], 0 offen offset:0
    buffer_load_dwordx4 v[20:23], v3, s[16:19], 0 offen offset:0
    buffer_load_dwordx4 v[8:11], v3, s[12:15], 0 offen offset:256
    buffer_load_dwordx4 v[24:27], v3, s[16:19], 0 offen offset:256
    buffer_load_dwordx4 v[12:15], v3, s[12:15], 0 offen offset:512
    buffer_load_dwordx4 v[28:31], v3, s[16:19], 0 offen offset:512
    buffer_load_dwordx4 v[16:19], v3, s[12:15], 0 offen offset:768
    buffer_load_dwordx4 v[32:35], v3, s[16:19], 0 offen offset:768
    s_waitcnt vmcnt(0)
    v_lshlrev_b32 v40, 16, v4
    v_and_b32 v41, 0xffff0000, v4
    v_lshlrev_b32 v42, 16, v5
    v_and_b32 v43, 0xffff0000, v5
    v_lshlrev_b32 v44, 16, v6
    v_and_b32 v45, 0xffff0000, v6
    v_lshlrev_b32 v46, 16, v7
    v_and_b32 v47, 0xffff0000, v7
    v_lshlrev_b32 v48, 16, v8
    v_and_b32 v49, 0xffff0000, v8
    v_lshlrev_b32 v50, 16, v9
    v_and_b32 v51, 0xffff0000, v9
    v_lshlrev_b32 v52, 16, v10
    v_and_b32 v53, 0xffff0000, v10
    v_lshlrev_b32 v54, 16, v11
    v_and_b32 v55, 0xffff0000, v11
    v_lshlrev_b32 v56, 16, v12
    v_and_b32 v57, 0xffff0000, v12
    v_lshlrev_b32 v58, 16, v13
    v_and_b32 v59, 0xffff0000, v13
    v_lshlrev_b32 v60, 16, v14
    v_and_b32 v61, 0xffff0000, v14
    v_lshlrev_b32 v62, 16, v15
    v_and_b32 v63, 0xffff0000, v15
    v_lshlrev_b32 v64, 16, v16
    v_and_b32 v65, 0xffff0000, v16
    v_lshlrev_b32 v66, 16, v17
    v_and_b32 v67, 0xffff0000, v17
    v_lshlrev_b32 v68, 16, v18
    v_and_b32 v69, 0xffff0000, v18
    v_lshlrev_b32 v70, 16, v19
    v_and_b32 v71, 0xffff0000, v19
    v_add_f32 v36, v40, v41
    v_add_f32 v36, v36, v42
    v_add_f32 v36, v36, v43
    v_add_f32 v36, v36, v44
    v_add_f32 v36, v36, v45
    v_add_f32 v36, v36, v46
    v_add_f32 v36, v36, v47
    v_add_f32 v36, v36, v48
    v_add_f32 v36, v36, v49
    v_add_f32 v36, v36, v50
    v_add_f32 v36, v36, v51
    v_add_f32 v36, v36, v52
    v_add_f32 v36, v36, v53
    v_add_f32 v36, v36, v54
    v_add_f32 v36, v36, v55
    v_add_f32 v36, v36, v56
    v_add_f32 v36, v36, v57
    v_add_f32 v36, v36, v58
    v_add_f32 v36, v36, v59
    v_add_f32 v36, v36, v60
    v_add_f32 v36, v36, v61
    v_add_f32 v36, v36, v62
    v_add_f32 v36, v36, v63
    v_add_f32 v36, v36, v64
    v_add_f32 v36, v36, v65
    v_add_f32 v36, v36, v66
    v_add_f32 v36, v36, v67
    v_add_f32 v36, v36, v68
    v_add_f32 v36, v36, v69
    v_add_f32 v36, v36, v70
    v_add_f32 v36, v36, v71
    ds_swizzle_b32 v37, v36 offset:1055
    s_waitcnt lgkmcnt(0)
    v_add_f32 v36, v36, v37
    ds_swizzle_b32 v37, v36 offset:2079
    s_waitcnt lgkmcnt(0)
    v_add_f32 v36, v36, v37
    ds_swizzle_b32 v37, v36 offset:4127
    s_waitcnt lgkmcnt(0)
    v_add_f32 v36, v36, v37
    ds_swizzle_b32 v37, v36 offset:8223
    s_waitcnt lgkmcnt(0)
    v_add_f32 v36, v36, v37
    v_mul_f32 v36, 0x3b000000, v36
    v_sub_f32 v37, v40, v36
    v_mul_f32 v38, v37, v37
    v_sub_f32 v37, v41, v36
    v_fmac_f32 v38, v37, v37
    v_sub_f32 v37, v42, v36
    v_fmac_f32 v38, v37, v37
    v_sub_f32 v37, v43, v36
    v_fmac_f32 v38, v37, v37
    v_sub_f32 v37, v44, v36
    v_fmac_f32 v38, v37, v37
    v_sub_f32 v37, v45, v36
    v_fmac_f32 v38, v37, v37
    v_sub_f32 v37, v46, v36
    v_fmac_f32 v38, v37, v37
    v_sub_f32 v37, v47, v36
    v_fmac_f32 v38, v37, v37
    v_sub_f32 v37, v48, v36
    v_fmac_f32 v38, v37, v37
    v_sub_f32 v37, v49, v36
    v_fmac_f32 v38, v37, v37
    v_sub_f32 v37, v50, v36
    v_fmac_f32 v38, v37, v37
    v_sub_f32 v37, v51, v36
    v_fmac_f32 v38, v37, v37
    v_sub_f32 v37, v52, v36
    v_fmac_f32 v38, v37, v37
    v_sub_f32 v37, v53, v36
    v_fmac_f32 v38, v37, v37
    v_sub_f32 v37, v54, v36
    v_fmac_f32 v38, v37, v37
    v_sub_f32 v37, v55, v36
    v_fmac_f32 v38, v37, v37
    v_sub_f32 v37, v56, v36
    v_fmac_f32 v38, v37, v37
    v_sub_f32 v37, v57, v36
    v_fmac_f32 v38, v37, v37
    v_sub_f32 v37, v58, v36
    v_fmac_f32 v38, v37, v37
    v_sub_f32 v37, v59, v36
    v_fmac_f32 v38, v37, v37
    v_sub_f32 v37, v60, v36
    v_fmac_f32 v38, v37, v37
    v_sub_f32 v37, v61, v36
    v_fmac_f32 v38, v37, v37
    v_sub_f32 v37, v62, v36
    v_fmac_f32 v38, v37, v37
    v_sub_f32 v37, v63, v36
    v_fmac_f32 v38, v37, v37
    v_sub_f32 v37, v64, v36
    v_fmac_f32 v38, v37, v37
    v_sub_f32 v37, v65, v36
    v_fmac_f32 v38, v37, v37
    v_sub_f32 v37, v66, v36
    v_fmac_f32 v38, v37, v37
    v_sub_f32 v37, v67, v36
    v_fmac_f32 v38, v37, v37
    v_sub_f32 v37, v68, v36
    v_fmac_f32 v38, v37, v37
    v_sub_f32 v37, v69, v36
    v_fmac_f32 v38, v37, v37
    v_sub_f32 v37, v70, v36
    v_fmac_f32 v38, v37, v37
    v_sub_f32 v37, v71, v36
    v_fmac_f32 v38, v37, v37
    ds_swizzle_b32 v37, v38 offset:1055
    s_waitcnt lgkmcnt(0)
    v_add_f32 v38, v38, v37
    ds_swizzle_b32 v37, v38 offset:2079
    s_waitcnt lgkmcnt(0)
    v_add_f32 v38, v38, v37
    ds_swizzle_b32 v37, v38 offset:4127
    s_waitcnt lgkmcnt(0)
    v_add_f32 v38, v38, v37
    ds_swizzle_b32 v37, v38 offset:8223
    s_waitcnt lgkmcnt(0)
    v_add_f32 v38, v38, v37
    v_mul_f32 v38, 0x3b000000, v38
    v_cvt_pk_bf16_f32 v37, v36, v38
    v_lshlrev_b32 v36, 16, v37
    v_and_b32 v38, 0xffff0000, v37
    v_add_f32 v38, 0x3727c5ac, v38
    v_mov_b32 v39, 0
    v_cvt_pk_bf16_f32 v37, v38, v39
    v_lshlrev_b32 v38, 16, v37
    v_and_b32 v39, 0xffff0000, v37
    v_sqrt_f32 v38, v38
    s_nop 0
    v_cvt_pk_bf16_f32 v37, v38, v39
    v_lshlrev_b32 v38, 16, v37
    v_and_b32 v39, 0xffff0000, v37
    v_rcp_f32 v38, v38
    s_nop 0
    v_sub_f32 v72, v40, v36
    v_sub_f32 v73, v41, v36
    v_cvt_pk_bf16_f32 v37, v72, v73
    v_lshlrev_b32 v72, 16, v37
    v_and_b32 v73, 0xffff0000, v37
    v_mul_f32 v72, v72, v38
    v_mul_f32 v73, v73, v38
    v_cvt_pk_bf16_f32 v37, v72, v73
    v_lshlrev_b32 v72, 16, v37
    v_and_b32 v73, 0xffff0000, v37
    v_sub_f32 v74, v42, v36
    v_sub_f32 v75, v43, v36
    v_cvt_pk_bf16_f32 v37, v74, v75
    v_lshlrev_b32 v74, 16, v37
    v_and_b32 v75, 0xffff0000, v37
    v_mul_f32 v74, v74, v38
    v_mul_f32 v75, v75, v38
    v_cvt_pk_bf16_f32 v37, v74, v75
    v_lshlrev_b32 v74, 16, v37
    v_and_b32 v75, 0xffff0000, v37
    v_sub_f32 v76, v44, v36
    v_sub_f32 v77, v45, v36
    v_cvt_pk_bf16_f32 v37, v76, v77
    v_lshlrev_b32 v76, 16, v37
    v_and_b32 v77, 0xffff0000, v37
    v_mul_f32 v76, v76, v38
    v_mul_f32 v77, v77, v38
    v_cvt_pk_bf16_f32 v37, v76, v77
    v_lshlrev_b32 v76, 16, v37
    v_and_b32 v77, 0xffff0000, v37
    v_sub_f32 v78, v46, v36
    v_sub_f32 v79, v47, v36
    v_cvt_pk_bf16_f32 v37, v78, v79
    v_lshlrev_b32 v78, 16, v37
    v_and_b32 v79, 0xffff0000, v37
    v_mul_f32 v78, v78, v38
    v_mul_f32 v79, v79, v38
    v_cvt_pk_bf16_f32 v37, v78, v79
    v_lshlrev_b32 v78, 16, v37
    v_and_b32 v79, 0xffff0000, v37
    v_sub_f32 v80, v48, v36
    v_sub_f32 v81, v49, v36
    v_cvt_pk_bf16_f32 v37, v80, v81
    v_lshlrev_b32 v80, 16, v37
    v_and_b32 v81, 0xffff0000, v37
    v_mul_f32 v80, v80, v38
    v_mul_f32 v81, v81, v38
    v_cvt_pk_bf16_f32 v37, v80, v81
    v_lshlrev_b32 v80, 16, v37
    v_and_b32 v81, 0xffff0000, v37
    v_sub_f32 v82, v50, v36
    v_sub_f32 v83, v51, v36
    v_cvt_pk_bf16_f32 v37, v82, v83
    v_lshlrev_b32 v82, 16, v37
    v_and_b32 v83, 0xffff0000, v37
    v_mul_f32 v82, v82, v38
    v_mul_f32 v83, v83, v38
    v_cvt_pk_bf16_f32 v37, v82, v83
    v_lshlrev_b32 v82, 16, v37
    v_and_b32 v83, 0xffff0000, v37
    v_sub_f32 v84, v52, v36
    v_sub_f32 v85, v53, v36
    v_cvt_pk_bf16_f32 v37, v84, v85
    v_lshlrev_b32 v84, 16, v37
    v_and_b32 v85, 0xffff0000, v37
    v_mul_f32 v84, v84, v38
    v_mul_f32 v85, v85, v38
    v_cvt_pk_bf16_f32 v37, v84, v85
    v_lshlrev_b32 v84, 16, v37
    v_and_b32 v85, 0xffff0000, v37
    v_sub_f32 v86, v54, v36
    v_sub_f32 v87, v55, v36
    v_cvt_pk_bf16_f32 v37, v86, v87
    v_lshlrev_b32 v86, 16, v37
    v_and_b32 v87, 0xffff0000, v37
    v_mul_f32 v86, v86, v38
    v_mul_f32 v87, v87, v38
    v_cvt_pk_bf16_f32 v37, v86, v87
    v_lshlrev_b32 v86, 16, v37
    v_and_b32 v87, 0xffff0000, v37
    v_sub_f32 v88, v56, v36
    v_sub_f32 v89, v57, v36
    v_cvt_pk_bf16_f32 v37, v88, v89
    v_lshlrev_b32 v88, 16, v37
    v_and_b32 v89, 0xffff0000, v37
    v_mul_f32 v88, v88, v38
    v_mul_f32 v89, v89, v38
    v_cvt_pk_bf16_f32 v37, v88, v89
    v_lshlrev_b32 v88, 16, v37
    v_and_b32 v89, 0xffff0000, v37
    v_sub_f32 v90, v58, v36
    v_sub_f32 v91, v59, v36
    v_cvt_pk_bf16_f32 v37, v90, v91
    v_lshlrev_b32 v90, 16, v37
    v_and_b32 v91, 0xffff0000, v37
    v_mul_f32 v90, v90, v38
    v_mul_f32 v91, v91, v38
    v_cvt_pk_bf16_f32 v37, v90, v91
    v_lshlrev_b32 v90, 16, v37
    v_and_b32 v91, 0xffff0000, v37
    v_sub_f32 v92, v60, v36
    v_sub_f32 v93, v61, v36
    v_cvt_pk_bf16_f32 v37, v92, v93
    v_lshlrev_b32 v92, 16, v37
    v_and_b32 v93, 0xffff0000, v37
    v_mul_f32 v92, v92, v38
    v_mul_f32 v93, v93, v38
    v_cvt_pk_bf16_f32 v37, v92, v93
    v_lshlrev_b32 v92, 16, v37
    v_and_b32 v93, 0xffff0000, v37
    v_sub_f32 v94, v62, v36
    v_sub_f32 v95, v63, v36
    v_cvt_pk_bf16_f32 v37, v94, v95
    v_lshlrev_b32 v94, 16, v37
    v_and_b32 v95, 0xffff0000, v37
    v_mul_f32 v94, v94, v38
    v_mul_f32 v95, v95, v38
    v_cvt_pk_bf16_f32 v37, v94, v95
    v_lshlrev_b32 v94, 16, v37
    v_and_b32 v95, 0xffff0000, v37
    v_sub_f32 v96, v64, v36
    v_sub_f32 v97, v65, v36
    v_cvt_pk_bf16_f32 v37, v96, v97
    v_lshlrev_b32 v96, 16, v37
    v_and_b32 v97, 0xffff0000, v37
    v_mul_f32 v96, v96, v38
    v_mul_f32 v97, v97, v38
    v_cvt_pk_bf16_f32 v37, v96, v97
    v_lshlrev_b32 v96, 16, v37
    v_and_b32 v97, 0xffff0000, v37
    v_sub_f32 v98, v66, v36
    v_sub_f32 v99, v67, v36
    v_cvt_pk_bf16_f32 v37, v98, v99
    v_lshlrev_b32 v98, 16, v37
    v_and_b32 v99, 0xffff0000, v37
    v_mul_f32 v98, v98, v38
    v_mul_f32 v99, v99, v38
    v_cvt_pk_bf16_f32 v37, v98, v99
    v_lshlrev_b32 v98, 16, v37
    v_and_b32 v99, 0xffff0000, v37
    v_sub_f32 v100, v68, v36
    v_sub_f32 v101, v69, v36
    v_cvt_pk_bf16_f32 v37, v100, v101
    v_lshlrev_b32 v100, 16, v37
    v_and_b32 v101, 0xffff0000, v37
    v_mul_f32 v100, v100, v38
    v_mul_f32 v101, v101, v38
    v_cvt_pk_bf16_f32 v37, v100, v101
    v_lshlrev_b32 v100, 16, v37
    v_and_b32 v101, 0xffff0000, v37
    v_sub_f32 v102, v70, v36
    v_sub_f32 v103, v71, v36
    v_cvt_pk_bf16_f32 v37, v102, v103
    v_lshlrev_b32 v102, 16, v37
    v_and_b32 v103, 0xffff0000, v37
    v_mul_f32 v102, v102, v38
    v_mul_f32 v103, v103, v38
    v_cvt_pk_bf16_f32 v37, v102, v103
    v_lshlrev_b32 v102, 16, v37
    v_and_b32 v103, 0xffff0000, v37
    v_lshlrev_b32 v104, 16, v20
    v_and_b32 v105, 0xffff0000, v20
    v_mul_f32 v104, v104, v72
    v_mul_f32 v105, v105, v73
    v_cvt_pk_bf16_f32 v37, v104, v105
    v_lshlrev_b32 v104, 16, v37
    v_and_b32 v105, 0xffff0000, v37
    v_add_f32 v104, v104, v40
    v_add_f32 v105, v105, v41
    v_cvt_pk_bf16_f32 v4, v104, v105
    v_lshlrev_b32 v104, 16, v4
    v_and_b32 v105, 0xffff0000, v4
    v_lshlrev_b32 v106, 16, v21
    v_and_b32 v107, 0xffff0000, v21
    v_mul_f32 v106, v106, v74
    v_mul_f32 v107, v107, v75
    v_cvt_pk_bf16_f32 v37, v106, v107
    v_lshlrev_b32 v106, 16, v37
    v_and_b32 v107, 0xffff0000, v37
    v_add_f32 v106, v106, v42
    v_add_f32 v107, v107, v43
    v_cvt_pk_bf16_f32 v5, v106, v107
    v_lshlrev_b32 v106, 16, v5
    v_and_b32 v107, 0xffff0000, v5
    v_lshlrev_b32 v108, 16, v22
    v_and_b32 v109, 0xffff0000, v22
    v_mul_f32 v108, v108, v76
    v_mul_f32 v109, v109, v77
    v_cvt_pk_bf16_f32 v37, v108, v109
    v_lshlrev_b32 v108, 16, v37
    v_and_b32 v109, 0xffff0000, v37
    v_add_f32 v108, v108, v44
    v_add_f32 v109, v109, v45
    v_cvt_pk_bf16_f32 v6, v108, v109
    v_lshlrev_b32 v108, 16, v6
    v_and_b32 v109, 0xffff0000, v6
    v_lshlrev_b32 v110, 16, v23
    v_and_b32 v111, 0xffff0000, v23
    v_mul_f32 v110, v110, v78
    v_mul_f32 v111, v111, v79
    v_cvt_pk_bf16_f32 v37, v110, v111
    v_lshlrev_b32 v110, 16, v37
    v_and_b32 v111, 0xffff0000, v37
    v_add_f32 v110, v110, v46
    v_add_f32 v111, v111, v47
    v_cvt_pk_bf16_f32 v7, v110, v111
    v_lshlrev_b32 v110, 16, v7
    v_and_b32 v111, 0xffff0000, v7
    v_lshlrev_b32 v112, 16, v24
    v_and_b32 v113, 0xffff0000, v24
    v_mul_f32 v112, v112, v80
    v_mul_f32 v113, v113, v81
    v_cvt_pk_bf16_f32 v37, v112, v113
    v_lshlrev_b32 v112, 16, v37
    v_and_b32 v113, 0xffff0000, v37
    v_add_f32 v112, v112, v48
    v_add_f32 v113, v113, v49
    v_cvt_pk_bf16_f32 v8, v112, v113
    v_lshlrev_b32 v112, 16, v8
    v_and_b32 v113, 0xffff0000, v8
    v_lshlrev_b32 v114, 16, v25
    v_and_b32 v115, 0xffff0000, v25
    v_mul_f32 v114, v114, v82
    v_mul_f32 v115, v115, v83
    v_cvt_pk_bf16_f32 v37, v114, v115
    v_lshlrev_b32 v114, 16, v37
    v_and_b32 v115, 0xffff0000, v37
    v_add_f32 v114, v114, v50
    v_add_f32 v115, v115, v51
    v_cvt_pk_bf16_f32 v9, v114, v115
    v_lshlrev_b32 v114, 16, v9
    v_and_b32 v115, 0xffff0000, v9
    v_lshlrev_b32 v116, 16, v26
    v_and_b32 v117, 0xffff0000, v26
    v_mul_f32 v116, v116, v84
    v_mul_f32 v117, v117, v85
    v_cvt_pk_bf16_f32 v37, v116, v117
    v_lshlrev_b32 v116, 16, v37
    v_and_b32 v117, 0xffff0000, v37
    v_add_f32 v116, v116, v52
    v_add_f32 v117, v117, v53
    v_cvt_pk_bf16_f32 v10, v116, v117
    v_lshlrev_b32 v116, 16, v10
    v_and_b32 v117, 0xffff0000, v10
    v_lshlrev_b32 v118, 16, v27
    v_and_b32 v119, 0xffff0000, v27
    v_mul_f32 v118, v118, v86
    v_mul_f32 v119, v119, v87
    v_cvt_pk_bf16_f32 v37, v118, v119
    v_lshlrev_b32 v118, 16, v37
    v_and_b32 v119, 0xffff0000, v37
    v_add_f32 v118, v118, v54
    v_add_f32 v119, v119, v55
    v_cvt_pk_bf16_f32 v11, v118, v119
    v_lshlrev_b32 v118, 16, v11
    v_and_b32 v119, 0xffff0000, v11
    v_lshlrev_b32 v120, 16, v28
    v_and_b32 v121, 0xffff0000, v28
    v_mul_f32 v120, v120, v88
    v_mul_f32 v121, v121, v89
    v_cvt_pk_bf16_f32 v37, v120, v121
    v_lshlrev_b32 v120, 16, v37
    v_and_b32 v121, 0xffff0000, v37
    v_add_f32 v120, v120, v56
    v_add_f32 v121, v121, v57
    v_cvt_pk_bf16_f32 v12, v120, v121
    v_lshlrev_b32 v120, 16, v12
    v_and_b32 v121, 0xffff0000, v12
    v_lshlrev_b32 v122, 16, v29
    v_and_b32 v123, 0xffff0000, v29
    v_mul_f32 v122, v122, v90
    v_mul_f32 v123, v123, v91
    v_cvt_pk_bf16_f32 v37, v122, v123
    v_lshlrev_b32 v122, 16, v37
    v_and_b32 v123, 0xffff0000, v37
    v_add_f32 v122, v122, v58
    v_add_f32 v123, v123, v59
    v_cvt_pk_bf16_f32 v13, v122, v123
    v_lshlrev_b32 v122, 16, v13
    v_and_b32 v123, 0xffff0000, v13
    v_lshlrev_b32 v124, 16, v30
    v_and_b32 v125, 0xffff0000, v30
    v_mul_f32 v124, v124, v92
    v_mul_f32 v125, v125, v93
    v_cvt_pk_bf16_f32 v37, v124, v125
    v_lshlrev_b32 v124, 16, v37
    v_and_b32 v125, 0xffff0000, v37
    v_add_f32 v124, v124, v60
    v_add_f32 v125, v125, v61
    v_cvt_pk_bf16_f32 v14, v124, v125
    v_lshlrev_b32 v124, 16, v14
    v_and_b32 v125, 0xffff0000, v14
    v_lshlrev_b32 v126, 16, v31
    v_and_b32 v127, 0xffff0000, v31
    v_mul_f32 v126, v126, v94
    v_mul_f32 v127, v127, v95
    v_cvt_pk_bf16_f32 v37, v126, v127
    v_lshlrev_b32 v126, 16, v37
    v_and_b32 v127, 0xffff0000, v37
    v_add_f32 v126, v126, v62
    v_add_f32 v127, v127, v63
    v_cvt_pk_bf16_f32 v15, v126, v127
    v_lshlrev_b32 v126, 16, v15
    v_and_b32 v127, 0xffff0000, v15
    v_lshlrev_b32 v128, 16, v32
    v_and_b32 v129, 0xffff0000, v32
    v_mul_f32 v128, v128, v96
    v_mul_f32 v129, v129, v97
    v_cvt_pk_bf16_f32 v37, v128, v129
    v_lshlrev_b32 v128, 16, v37
    v_and_b32 v129, 0xffff0000, v37
    v_add_f32 v128, v128, v64
    v_add_f32 v129, v129, v65
    v_cvt_pk_bf16_f32 v16, v128, v129
    v_lshlrev_b32 v128, 16, v16
    v_and_b32 v129, 0xffff0000, v16
    v_lshlrev_b32 v130, 16, v33
    v_and_b32 v131, 0xffff0000, v33
    v_mul_f32 v130, v130, v98
    v_mul_f32 v131, v131, v99
    v_cvt_pk_bf16_f32 v37, v130, v131
    v_lshlrev_b32 v130, 16, v37
    v_and_b32 v131, 0xffff0000, v37
    v_add_f32 v130, v130, v66
    v_add_f32 v131, v131, v67
    v_cvt_pk_bf16_f32 v17, v130, v131
    v_lshlrev_b32 v130, 16, v17
    v_and_b32 v131, 0xffff0000, v17
    v_lshlrev_b32 v132, 16, v34
    v_and_b32 v133, 0xffff0000, v34
    v_mul_f32 v132, v132, v100
    v_mul_f32 v133, v133, v101
    v_cvt_pk_bf16_f32 v37, v132, v133
    v_lshlrev_b32 v132, 16, v37
    v_and_b32 v133, 0xffff0000, v37
    v_add_f32 v132, v132, v68
    v_add_f32 v133, v133, v69
    v_cvt_pk_bf16_f32 v18, v132, v133
    v_lshlrev_b32 v132, 16, v18
    v_and_b32 v133, 0xffff0000, v18
    v_lshlrev_b32 v134, 16, v35
    v_and_b32 v135, 0xffff0000, v35
    v_mul_f32 v134, v134, v102
    v_mul_f32 v135, v135, v103
    v_cvt_pk_bf16_f32 v37, v134, v135
    v_lshlrev_b32 v134, 16, v37
    v_and_b32 v135, 0xffff0000, v37
    v_add_f32 v134, v134, v70
    v_add_f32 v135, v135, v71
    v_cvt_pk_bf16_f32 v19, v134, v135
    v_lshlrev_b32 v134, 16, v19
    v_and_b32 v135, 0xffff0000, v19
    buffer_store_dwordx4 v[4:7], v3, s[20:23], 0 offen offset:0
    buffer_store_dwordx4 v[8:11], v3, s[20:23], 0 offen offset:256
    buffer_store_dwordx4 v[12:15], v3, s[20:23], 0 offen offset:512
    buffer_store_dwordx4 v[16:19], v3, s[20:23], 0 offen offset:768
    v_add_f32 v36, v104, v105
    v_add_f32 v36, v36, v106
    v_add_f32 v36, v36, v107
    v_add_f32 v36, v36, v108
    v_add_f32 v36, v36, v109
    v_add_f32 v36, v36, v110
    v_add_f32 v36, v36, v111
    v_add_f32 v36, v36, v112
    v_add_f32 v36, v36, v113
    v_add_f32 v36, v36, v114
    v_add_f32 v36, v36, v115
    v_add_f32 v36, v36, v116
    v_add_f32 v36, v36, v117
    v_add_f32 v36, v36, v118
    v_add_f32 v36, v36, v119
    v_add_f32 v36, v36, v120
    v_add_f32 v36, v36, v121
    v_add_f32 v36, v36, v122
    v_add_f32 v36, v36, v123
    v_add_f32 v36, v36, v124
    v_add_f32 v36, v36, v125
    v_add_f32 v36, v36, v126
    v_add_f32 v36, v36, v127
    v_add_f32 v36, v36, v128
    v_add_f32 v36, v36, v129
    v_add_f32 v36, v36, v130
    v_add_f32 v36, v36, v131
    v_add_f32 v36, v36, v132
    v_add_f32 v36, v36, v133
    v_add_f32 v36, v36, v134
    v_add_f32 v36, v36, v135
    ds_swizzle_b32 v37, v36 offset:1055
    s_waitcnt lgkmcnt(0)
    v_add_f32 v36, v36, v37
    ds_swizzle_b32 v37, v36 offset:2079
    s_waitcnt lgkmcnt(0)
    v_add_f32 v36, v36, v37
    ds_swizzle_b32 v37, v36 offset:4127
    s_waitcnt lgkmcnt(0)
    v_add_f32 v36, v36, v37
    ds_swizzle_b32 v37, v36 offset:8223
    s_waitcnt lgkmcnt(0)
    v_add_f32 v36, v36, v37
    v_mul_f32 v36, 0x3b000000, v36
    v_sub_f32 v37, v104, v36
    v_mul_f32 v38, v37, v37
    v_sub_f32 v37, v105, v36
    v_fmac_f32 v38, v37, v37
    v_sub_f32 v37, v106, v36
    v_fmac_f32 v38, v37, v37
    v_sub_f32 v37, v107, v36
    v_fmac_f32 v38, v37, v37
    v_sub_f32 v37, v108, v36
    v_fmac_f32 v38, v37, v37
    v_sub_f32 v37, v109, v36
    v_fmac_f32 v38, v37, v37
    v_sub_f32 v37, v110, v36
    v_fmac_f32 v38, v37, v37
    v_sub_f32 v37, v111, v36
    v_fmac_f32 v38, v37, v37
    v_sub_f32 v37, v112, v36
    v_fmac_f32 v38, v37, v37
    v_sub_f32 v37, v113, v36
    v_fmac_f32 v38, v37, v37
    v_sub_f32 v37, v114, v36
    v_fmac_f32 v38, v37, v37
    v_sub_f32 v37, v115, v36
    v_fmac_f32 v38, v37, v37
    v_sub_f32 v37, v116, v36
    v_fmac_f32 v38, v37, v37
    v_sub_f32 v37, v117, v36
    v_fmac_f32 v38, v37, v37
    v_sub_f32 v37, v118, v36
    v_fmac_f32 v38, v37, v37
    v_sub_f32 v37, v119, v36
    v_fmac_f32 v38, v37, v37
    v_sub_f32 v37, v120, v36
    v_fmac_f32 v38, v37, v37
    v_sub_f32 v37, v121, v36
    v_fmac_f32 v38, v37, v37
    v_sub_f32 v37, v122, v36
    v_fmac_f32 v38, v37, v37
    v_sub_f32 v37, v123, v36
    v_fmac_f32 v38, v37, v37
    v_sub_f32 v37, v124, v36
    v_fmac_f32 v38, v37, v37
    v_sub_f32 v37, v125, v36
    v_fmac_f32 v38, v37, v37
    v_sub_f32 v37, v126, v36
    v_fmac_f32 v38, v37, v37
    v_sub_f32 v37, v127, v36
    v_fmac_f32 v38, v37, v37
    v_sub_f32 v37, v128, v36
    v_fmac_f32 v38, v37, v37
    v_sub_f32 v37, v129, v36
    v_fmac_f32 v38, v37, v37
    v_sub_f32 v37, v130, v36
    v_fmac_f32 v38, v37, v37
    v_sub_f32 v37, v131, v36
    v_fmac_f32 v38, v37, v37
    v_sub_f32 v37, v132, v36
    v_fmac_f32 v38, v37, v37
    v_sub_f32 v37, v133, v36
    v_fmac_f32 v38, v37, v37
    v_sub_f32 v37, v134, v36
    v_fmac_f32 v38, v37, v37
    v_sub_f32 v37, v135, v36
    v_fmac_f32 v38, v37, v37
    ds_swizzle_b32 v37, v38 offset:1055
    s_waitcnt lgkmcnt(0)
    v_add_f32 v38, v38, v37
    ds_swizzle_b32 v37, v38 offset:2079
    s_waitcnt lgkmcnt(0)
    v_add_f32 v38, v38, v37
    ds_swizzle_b32 v37, v38 offset:4127
    s_waitcnt lgkmcnt(0)
    v_add_f32 v38, v38, v37
    ds_swizzle_b32 v37, v38 offset:8223
    s_waitcnt lgkmcnt(0)
    v_add_f32 v38, v38, v37
    v_mul_f32 v38, 0x3b000000, v38
    v_cvt_pk_bf16_f32 v37, v36, v38
    v_lshlrev_b32 v36, 16, v37
    v_and_b32 v38, 0xffff0000, v37
    v_add_f32 v38, 0x3727c5ac, v38
    v_mov_b32 v39, 0
    v_cvt_pk_bf16_f32 v37, v38, v39
    v_lshlrev_b32 v38, 16, v37
    v_and_b32 v39, 0xffff0000, v37
    v_sqrt_f32 v38, v38
    s_nop 0
    v_cvt_pk_bf16_f32 v37, v38, v39
    v_lshlrev_b32 v38, 16, v37
    v_and_b32 v39, 0xffff0000, v37
    v_rcp_f32 v38, v38
    s_nop 0
    v_sub_f32 v72, v104, v36
    v_sub_f32 v73, v105, v36
    v_cvt_pk_bf16_f32 v37, v72, v73
    v_lshlrev_b32 v72, 16, v37
    v_and_b32 v73, 0xffff0000, v37
    v_mul_f32 v72, v72, v38
    v_mul_f32 v73, v73, v38
    v_cvt_pk_bf16_f32 v37, v72, v73
    v_lshlrev_b32 v72, 16, v37
    v_and_b32 v73, 0xffff0000, v37
    v_sub_f32 v74, v106, v36
    v_sub_f32 v75, v107, v36
    v_cvt_pk_bf16_f32 v37, v74, v75
    v_lshlrev_b32 v74, 16, v37
    v_and_b32 v75, 0xffff0000, v37
    v_mul_f32 v74, v74, v38
    v_mul_f32 v75, v75, v38
    v_cvt_pk_bf16_f32 v37, v74, v75
    v_lshlrev_b32 v74, 16, v37
    v_and_b32 v75, 0xffff0000, v37
    v_sub_f32 v76, v108, v36
    v_sub_f32 v77, v109, v36
    v_cvt_pk_bf16_f32 v37, v76, v77
    v_lshlrev_b32 v76, 16, v37
    v_and_b32 v77, 0xffff0000, v37
    v_mul_f32 v76, v76, v38
    v_mul_f32 v77, v77, v38
    v_cvt_pk_bf16_f32 v37, v76, v77
    v_lshlrev_b32 v76, 16, v37
    v_and_b32 v77, 0xffff0000, v37
    v_sub_f32 v78, v110, v36
    v_sub_f32 v79, v111, v36
    v_cvt_pk_bf16_f32 v37, v78, v79
    v_lshlrev_b32 v78, 16, v37
    v_and_b32 v79, 0xffff0000, v37
    v_mul_f32 v78, v78, v38
    v_mul_f32 v79, v79, v38
    v_cvt_pk_bf16_f32 v37, v78, v79
    v_lshlrev_b32 v78, 16, v37
    v_and_b32 v79, 0xffff0000, v37
    v_sub_f32 v80, v112, v36
    v_sub_f32 v81, v113, v36
    v_cvt_pk_bf16_f32 v37, v80, v81
    v_lshlrev_b32 v80, 16, v37
    v_and_b32 v81, 0xffff0000, v37
    v_mul_f32 v80, v80, v38
    v_mul_f32 v81, v81, v38
    v_cvt_pk_bf16_f32 v37, v80, v81
    v_lshlrev_b32 v80, 16, v37
    v_and_b32 v81, 0xffff0000, v37
    v_sub_f32 v82, v114, v36
    v_sub_f32 v83, v115, v36
    v_cvt_pk_bf16_f32 v37, v82, v83
    v_lshlrev_b32 v82, 16, v37
    v_and_b32 v83, 0xffff0000, v37
    v_mul_f32 v82, v82, v38
    v_mul_f32 v83, v83, v38
    v_cvt_pk_bf16_f32 v37, v82, v83
    v_lshlrev_b32 v82, 16, v37
    v_and_b32 v83, 0xffff0000, v37
    v_sub_f32 v84, v116, v36
    v_sub_f32 v85, v117, v36
    v_cvt_pk_bf16_f32 v37, v84, v85
    v_lshlrev_b32 v84, 16, v37
    v_and_b32 v85, 0xffff0000, v37
    v_mul_f32 v84, v84, v38
    v_mul_f32 v85, v85, v38
    v_cvt_pk_bf16_f32 v37, v84, v85
    v_lshlrev_b32 v84, 16, v37
    v_and_b32 v85, 0xffff0000, v37
    v_sub_f32 v86, v118, v36
    v_sub_f32 v87, v119, v36
    v_cvt_pk_bf16_f32 v37, v86, v87
    v_lshlrev_b32 v86, 16, v37
    v_and_b32 v87, 0xffff0000, v37
    v_mul_f32 v86, v86, v38
    v_mul_f32 v87, v87, v38
    v_cvt_pk_bf16_f32 v37, v86, v87
    v_lshlrev_b32 v86, 16, v37
    v_and_b32 v87, 0xffff0000, v37
    v_sub_f32 v88, v120, v36
    v_sub_f32 v89, v121, v36
    v_cvt_pk_bf16_f32 v37, v88, v89
    v_lshlrev_b32 v88, 16, v37
    v_and_b32 v89, 0xffff0000, v37
    v_mul_f32 v88, v88, v38
    v_mul_f32 v89, v89, v38
    v_cvt_pk_bf16_f32 v37, v88, v89
    v_lshlrev_b32 v88, 16, v37
    v_and_b32 v89, 0xffff0000, v37
    v_sub_f32 v90, v122, v36
    v_sub_f32 v91, v123, v36
    v_cvt_pk_bf16_f32 v37, v90, v91
    v_lshlrev_b32 v90, 16, v37
    v_and_b32 v91, 0xffff0000, v37
    v_mul_f32 v90, v90, v38
    v_mul_f32 v91, v91, v38
    v_cvt_pk_bf16_f32 v37, v90, v91
    v_lshlrev_b32 v90, 16, v37
    v_and_b32 v91, 0xffff0000, v37
    v_sub_f32 v92, v124, v36
    v_sub_f32 v93, v125, v36
    v_cvt_pk_bf16_f32 v37, v92, v93
    v_lshlrev_b32 v92, 16, v37
    v_and_b32 v93, 0xffff0000, v37
    v_mul_f32 v92, v92, v38
    v_mul_f32 v93, v93, v38
    v_cvt_pk_bf16_f32 v37, v92, v93
    v_lshlrev_b32 v92, 16, v37
    v_and_b32 v93, 0xffff0000, v37
    v_sub_f32 v94, v126, v36
    v_sub_f32 v95, v127, v36
    v_cvt_pk_bf16_f32 v37, v94, v95
    v_lshlrev_b32 v94, 16, v37
    v_and_b32 v95, 0xffff0000, v37
    v_mul_f32 v94, v94, v38
    v_mul_f32 v95, v95, v38
    v_cvt_pk_bf16_f32 v37, v94, v95
    v_lshlrev_b32 v94, 16, v37
    v_and_b32 v95, 0xffff0000, v37
    v_sub_f32 v96, v128, v36
    v_sub_f32 v97, v129, v36
    v_cvt_pk_bf16_f32 v37, v96, v97
    v_lshlrev_b32 v96, 16, v37
    v_and_b32 v97, 0xffff0000, v37
    v_mul_f32 v96, v96, v38
    v_mul_f32 v97, v97, v38
    v_cvt_pk_bf16_f32 v37, v96, v97
    v_lshlrev_b32 v96, 16, v37
    v_and_b32 v97, 0xffff0000, v37
    v_sub_f32 v98, v130, v36
    v_sub_f32 v99, v131, v36
    v_cvt_pk_bf16_f32 v37, v98, v99
    v_lshlrev_b32 v98, 16, v37
    v_and_b32 v99, 0xffff0000, v37
    v_mul_f32 v98, v98, v38
    v_mul_f32 v99, v99, v38
    v_cvt_pk_bf16_f32 v37, v98, v99
    v_lshlrev_b32 v98, 16, v37
    v_and_b32 v99, 0xffff0000, v37
    v_sub_f32 v100, v132, v36
    v_sub_f32 v101, v133, v36
    v_cvt_pk_bf16_f32 v37, v100, v101
    v_lshlrev_b32 v100, 16, v37
    v_and_b32 v101, 0xffff0000, v37
    v_mul_f32 v100, v100, v38
    v_mul_f32 v101, v101, v38
    v_cvt_pk_bf16_f32 v37, v100, v101
    v_lshlrev_b32 v100, 16, v37
    v_and_b32 v101, 0xffff0000, v37
    v_sub_f32 v102, v134, v36
    v_sub_f32 v103, v135, v36
    v_cvt_pk_bf16_f32 v37, v102, v103
    v_lshlrev_b32 v102, 16, v37
    v_and_b32 v103, 0xffff0000, v37
    v_mul_f32 v102, v102, v38
    v_mul_f32 v103, v103, v38
    v_cvt_pk_bf16_f32 v37, v102, v103
    v_lshlrev_b32 v102, 16, v37
    v_and_b32 v103, 0xffff0000, v37
    v_cvt_pk_bf16_f32 v20, v72, v73
    v_cvt_pk_bf16_f32 v21, v74, v75
    v_cvt_pk_bf16_f32 v22, v76, v77
    v_cvt_pk_bf16_f32 v23, v78, v79
    v_cvt_pk_bf16_f32 v24, v80, v81
    v_cvt_pk_bf16_f32 v25, v82, v83
    v_cvt_pk_bf16_f32 v26, v84, v85
    v_cvt_pk_bf16_f32 v27, v86, v87
    v_cvt_pk_bf16_f32 v28, v88, v89
    v_cvt_pk_bf16_f32 v29, v90, v91
    v_cvt_pk_bf16_f32 v30, v92, v93
    v_cvt_pk_bf16_f32 v31, v94, v95
    v_cvt_pk_bf16_f32 v32, v96, v97
    v_cvt_pk_bf16_f32 v33, v98, v99
    v_cvt_pk_bf16_f32 v34, v100, v101
    v_cvt_pk_bf16_f32 v35, v102, v103
    v_and_b32 v36, 3, v2
    v_lshrrev_b32 v37, 2, v2
    v_lshlrev_b32 v36, 8, v36
    v_lshl_add_u32 v36, v37, 10, v36
    v_lshl_add_u32 v36, v1, 4, v36
    v_add_u32 v36, s28, v36
    s_mov_b32 s29, 0
    buffer_store_dwordx4 v[20:23], v36, s[24:27], s29 offen
    s_mov_b32 s29, 4096
    buffer_store_dwordx4 v[24:27], v36, s[24:27], s29 offen
    s_mov_b32 s29, 8192
    buffer_store_dwordx4 v[28:31], v36, s[24:27], s29 offen
    s_mov_b32 s29, 12288
    buffer_store_dwordx4 v[32:35], v36, s[24:27], s29 offen
ln_end:
    s_endpgm
.globl g1_kernel
.p2align 8
.type g1_kernel,@function
g1_kernel:
    s_cmp_ge_u32 s2, 224
    s_cbranch_scc1 g1_end
    s_load_dwordx2 s[10:11], s[0:1], 96
    s_waitcnt lgkmcnt(0)
    s_add_u32 s12, s10, 6291456
    s_addc_u32 s13, s11, 0
    s_mov_b32 s14, 2097152
    s_mov_b32 s15, 0x20000
    s_add_u32 s16, s10, 8388608
    s_addc_u32 s17, s11, 0
    s_mov_b32 s18, 2097152
    s_mov_b32 s19, 0x20000
    s_add_u32 s20, s10, 10485760
    s_addc_u32 s21, s11, 0
    s_mov_b32 s22, 2097152
    s_mov_b32 s23, 0x20000
    s_add_u32 s24, s10, 16777216
    s_addc_u32 s25, s11, 0
    s_mov_b32 s26, 8388608
    s_mov_b32 s27, 0x20000
    s_and_b32 s28, s2, 15
    s_lshr_b32 s29, s2, 4
    v_lshrrev_b32 v1, 6, v0
    v_and_b32 v2, 63, v0
    v_and_b32 v3, 15, v2
    v_lshrrev_b32 v4, 4, v2
    v_lshrrev_b32 v5, 1, v1
    v_and_b32 v6, 1, v1
    v_lshlrev_b32 v7, 16, v5
    v_lshl_add_u32 v7, v2, 4, v7
    s_lshl_b32 s30, s28, 17
    v_add_u32 v7, s30, v7
    v_lshlrev_b32 v8, 16, v6
    v_lshl_add_u32 v8, v2, 4, v8
    s_lshl_b32 s30, s29, 17
    v_add_u32 v8, s30, v8
    v_accvgpr_write_b32 a0, 0
    v_accvgpr_write_b32 a1, 0
    v_accvgpr_write_b32 a2, 0
    v_accvgpr_write_b32 a3, 0
    v_accvgpr_write_b32 a4, 0
    v_accvgpr_write_b32 a5, 0
    v_accvgpr_write_b32 a6, 0
    v_accvgpr_write_b32 a7, 0
    v_accvgpr_write_b32 a8, 0
    v_accvgpr_write_b32 a9, 0
    v_accvgpr_write_b32 a10, 0
    v_accvgpr_write_b32 a11, 0
    v_accvgpr_write_b32 a12, 0
    v_accvgpr_write_b32 a13, 0
    v_accvgpr_write_b32 a14, 0
    v_accvgpr_write_b32 a15, 0
    v_accvgpr_write_b32 a16, 0
    v_accvgpr_write_b32 a17, 0
    v_accvgpr_write_b32 a18, 0
    v_accvgpr_write_b32 a19, 0
    v_accvgpr_write_b32 a20, 0
    v_accvgpr_write_b32 a21, 0
    v_accvgpr_write_b32 a22, 0
    v_accvgpr_write_b32 a23, 0
    v_accvgpr_write_b32 a24, 0
    v_accvgpr_write_b32 a25, 0
    v_accvgpr_write_b32 a26, 0
    v_accvgpr_write_b32 a27, 0
    v_accvgpr_write_b32 a28, 0
    v_accvgpr_write_b32 a29, 0
    v_accvgpr_write_b32 a30, 0
    v_accvgpr_write_b32 a31, 0
    v_accvgpr_write_b32 a32, 0
    v_accvgpr_write_b32 a33, 0
    v_accvgpr_write_b32 a34, 0
    v_accvgpr_write_b32 a35, 0
    v_accvgpr_write_b32 a36, 0
    v_accvgpr_write_b32 a37, 0
    v_accvgpr_write_b32 a38, 0
    v_accvgpr_write_b32 a39, 0
    v_accvgpr_write_b32 a40, 0
    v_accvgpr_write_b32 a41, 0
    v_accvgpr_write_b32 a42, 0
    v_accvgpr_write_b32 a43, 0
    v_accvgpr_write_b32 a44, 0
    v_accvgpr_write_b32 a45, 0
    v_accvgpr_write_b32 a46, 0
    v_accvgpr_write_b32 a47, 0
    v_accvgpr_write_b32 a48, 0
    v_accvgpr_write_b32 a49, 0
    v_accvgpr_write_b32 a50, 0
    v_accvgpr_write_b32 a51, 0
    v_accvgpr_write_b32 a52, 0
    v_accvgpr_write_b32 a53, 0
    v_accvgpr_write_b32 a54, 0
    v_accvgpr_write_b32 a55, 0
    v_accvgpr_write_b32 a56, 0
    v_accvgpr_write_b32 a57, 0
    v_accvgpr_write_b32 a58, 0
    v_accvgpr_write_b32 a59, 0
    v_accvgpr_write_b32 a60, 0
    v_accvgpr_write_b32 a61, 0
    v_accvgpr_write_b32 a62, 0
    v_accvgpr_write_b32 a63, 0
    v_accvgpr_write_b32 a64, 0
    v_accvgpr_write_b32 a65, 0
    v_accvgpr_write_b32 a66, 0
    v_accvgpr_write_b32 a67, 0
    v_accvgpr_write_b32 a68, 0
    v_accvgpr_write_b32 a69, 0
    v_accvgpr_write_b32 a70, 0
    v_accvgpr_write_b32 a71, 0
    v_accvgpr_write_b32 a72, 0
    v_accvgpr_write_b32 a73, 0
    v_accvgpr_write_b32 a74, 0
    v_accvgpr_write_b32 a75, 0
    v_accvgpr_write_b32 a76, 0
    v_accvgpr_write_b32 a77, 0
    v_accvgpr_write_b32 a78, 0
    v_accvgpr_write_b32 a79, 0
    v_accvgpr_write_b32 a80, 0
    v_accvgpr_write_b32 a81, 0
    v_accvgpr_write_b32 a82, 0
    v_accvgpr_write_b32 a83, 0
    v_accvgpr_write_b32 a84, 0
    v_accvgpr_write_b32 a85, 0
    v_accvgpr_write_b32 a86, 0
    v_accvgpr_write_b32 a87, 0
    v_accvgpr_write_b32 a88, 0
    v_accvgpr_write_b32 a89, 0
    v_accvgpr_write_b32 a90, 0
    v_accvgpr_write_b32 a91, 0
    v_accvgpr_write_b32 a92, 0
    v_accvgpr_write_b32 a93, 0
    v_accvgpr_write_b32 a94, 0
    v_accvgpr_write_b32 a95, 0
    v_accvgpr_write_b32 a96, 0
    v_accvgpr_write_b32 a97, 0
    v_accvgpr_write_b32 a98, 0
    v_accvgpr_write_b32 a99, 0
    v_accvgpr_write_b32 a100, 0
    v_accvgpr_write_b32 a101, 0
    v_accvgpr_write_b32 a102, 0
    v_accvgpr_write_b32 a103, 0
    v_accvgpr_write_b32 a104, 0
    v_accvgpr_write_b32 a105, 0
    v_accvgpr_write_b32 a106, 0
    v_accvgpr_write_b32 a107, 0
    v_accvgpr_write_b32 a108, 0
    v_accvgpr_write_b32 a109, 0
    v_accvgpr_write_b32 a110, 0
    v_accvgpr_write_b32 a111, 0
    v_accvgpr_write_b32 a112, 0
    v_accvgpr_write_b32 a113, 0
    v_accvgpr_write_b32 a114, 0
    v_accvgpr_write_b32 a115, 0
    v_accvgpr_write_b32 a116, 0
    v_accvgpr_write_b32 a117, 0
    v_accvgpr_write_b32 a118, 0
    v_accvgpr_write_b32 a119, 0
    v_accvgpr_write_b32 a120, 0
    v_accvgpr_write_b32 a121, 0
    v_accvgpr_write_b32 a122, 0
    v_accvgpr_write_b32 a123, 0
    v_accvgpr_write_b32 a124, 0
    v_accvgpr_write_b32 a125, 0
    v_accvgpr_write_b32 a126, 0
    v_accvgpr_write_b32 a127, 0
    v_add_u32 v10, 16384, v7
    v_add_u32 v11, 32768, v7
    v_add_u32 v12, 49152, v7
    v_add_u32 v13, 16384, v8
    v_add_u32 v14, 32768, v8
    v_add_u32 v15, 49152, v8
    s_mov_b32 s31, 0
    buffer_load_dwordx4 v[16:19], v7, s[12:15], s31 offen
    buffer_load_dwordx4 v[20:23], v10, s[12:15], s31 offen
    buffer_load_dwordx4 v[24:27], v11, s[12:15], s31 offen
    buffer_load_dwordx4 v[28:31], v12, s[12:15], s31 offen
    buffer_load_dwordx4 v[32:35], v8, s[16:19], s31 offen
    buffer_load_dwordx4 v[36:39], v13, s[16:19], s31 offen
    buffer_load_dwordx4 v[40:43], v14, s[16:19], s31 offen
    buffer_load_dwordx4 v[44:47], v15, s[16:19], s31 offen
    buffer_load_dwordx4 v[48:51], v8, s[20:23], s31 offen
    buffer_load_dwordx4 v[52:55], v13, s[20:23], s31 offen
    buffer_load_dwordx4 v[56:59], v14, s[20:23], s31 offen
    buffer_load_dwordx4 v[60:63], v15, s[20:23], s31 offen
    s_mov_b32 s31, 1024
    buffer_load_dwordx4 v[64:67], v7, s[12:15], s31 offen
    buffer_load_dwordx4 v[68:71], v10, s[12:15], s31 offen
    buffer_load_dwordx4 v[72:75], v11, s[12:15], s31 offen
    buffer_load_dwordx4 v[76:79], v12, s[12:15], s31 offen
    buffer_load_dwordx4 v[80:83], v8, s[16:19], s31 offen
    buffer_load_dwordx4 v[84:87], v13, s[16:19], s31 offen
    buffer_load_dwordx4 v[88:91], v14, s[16:19], s31 offen
    buffer_load_dwordx4 v[92:95], v15, s[16:19], s31 offen
    buffer_load_dwordx4 v[96:99], v8, s[20:23], s31 offen
    buffer_load_dwordx4 v[100:103], v13, s[20:23], s31 offen
    buffer_load_dwordx4 v[104:107], v14, s[20:23], s31 offen
    buffer_load_dwordx4 v[108:111], v15, s[20:23], s31 offen
    s_mov_b32 s31, 2048
    buffer_load_dwordx4 v[112:115], v7, s[12:15], s31 offen
    buffer_load_dwordx4 v[116:119], v10, s[12:15], s31 offen
    buffer_load_dwordx4 v[120:123], v11, s[12:15], s31 offen
    buffer_load_dwordx4 v[124:127], v12, s[12:15], s31 offen
    buffer_load_dwordx4 v[128:131], v8, s[16:19], s31 offen
    buffer_load_dwordx4 v[132:135], v13, s[16:19], s31 offen
    buffer_load_dwordx4 v[136:139], v14, s[16:19], s31 offen
    buffer_load_dwordx4 v[140:143], v15, s[16:19], s31 offen
    buffer_load_dwordx4 v[144:147], v8, s[20:23], s31 offen
    buffer_load_dwordx4 v[148:151], v13, s[20:23], s31 offen
    buffer_load_dwordx4 v[152:155], v14, s[20:23], s31 offen
    buffer_load_dwordx4 v[156:159], v15, s[20:23], s31 offen
    s_mov_b32 s31, 3072
    buffer_load_dwordx4 v[160:163], v7, s[12:15], s31 offen
    buffer_load_dwordx4 v[164:167], v10, s[12:15], s31 offen
    buffer_load_dwordx4 v[168:171], v11, s[12:15], s31 offen
    buffer_load_dwordx4 v[172:175], v12, s[12:15], s31 offen
    buffer_load_dwordx4 v[176:179], v8, s[16:19], s31 offen
    buffer_load_dwordx4 v[180:183], v13, s[16:19], s31 offen
    buffer_load_dwordx4 v[184:187], v14, s[16:19], s31 offen
    buffer_load_dwordx4 v[188:191], v15, s[16:19], s31 offen
    buffer_load_dwordx4 v[192:195], v8, s[20:23], s31 offen
    buffer_load_dwordx4 v[196:199], v13, s[20:23], s31 offen
    buffer_load_dwordx4 v[200:203], v14, s[20:23], s31 offen
    buffer_load_dwordx4 v[204:207], v15, s[20:23], s31 offen
    s_waitcnt vmcnt(36)
    v_mfma_f32_16x16x32_bf16 a[0:3], v[32:35], v[16:19], a[0:3]
    v_mfma_f32_16x16x32_bf16 a[4:7], v[36:39], v[16:19], a[4:7]
    v_mfma_f32_16x16x32_bf16 a[8:11], v[40:43], v[16:19], a[8:11]
    v_mfma_f32_16x16x32_bf16 a[12:15], v[44:47], v[16:19], a[12:15]
    v_mfma_f32_16x16x32_bf16 a[16:19], v[48:51], v[16:19], a[16:19]
    v_mfma_f32_16x16x32_bf16 a[20:23], v[52:55], v[16:19], a[20:23]
    v_mfma_f32_16x16x32_bf16 a[24:27], v[56:59], v[16:19], a[24:27]
    v_mfma_f32_16x16x32_bf16 a[28:31], v[60:63], v[16:19], a[28:31]
    v_mfma_f32_16x16x32_bf16 a[32:35], v[32:35], v[20:23], a[32:35]
    v_mfma_f32_16x16x32_bf16 a[36:39], v[36:39], v[20:23], a[36:39]
    v_mfma_f32_16x16x32_bf16 a[40:43], v[40:43], v[20:23], a[40:43]
    v_mfma_f32_16x16x32_bf16 a[44:47], v[44:47], v[20:23], a[44:47]
    v_mfma_f32_16x16x32_bf16 a[48:51], v[48:51], v[20:23], a[48:51]
    v_mfma_f32_16x16x32_bf16 a[52:55], v[52:55], v[20:23], a[52:55]
    v_mfma_f32_16x16x32_bf16 a[56:59], v[56:59], v[20:23], a[56:59]
    v_mfma_f32_16x16x32_bf16 a[60:63], v[60:63], v[20:23], a[60:63]
    v_mfma_f32_16x16x32_bf16 a[64:67], v[32:35], v[24:27], a[64:67]
    v_mfma_f32_16x16x32_bf16 a[68:71], v[36:39], v[24:27], a[68:71]
    v_mfma_f32_16x16x32_bf16 a[72:75], v[40:43], v[24:27], a[72:75]
    v_mfma_f32_16x16x32_bf16 a[76:79], v[44:47], v[24:27], a[76:79]
    v_mfma_f32_16x16x32_bf16 a[80:83], v[48:51], v[24:27], a[80:83]
    v_mfma_f32_16x16x32_bf16 a[84:87], v[52:55], v[24:27], a[84:87]
    v_mfma_f32_16x16x32_bf16 a[88:91], v[56:59], v[24:27], a[88:91]
    v_mfma_f32_16x16x32_bf16 a[92:95], v[60:63], v[24:27], a[92:95]
    v_mfma_f32_16x16x32_bf16 a[96:99], v[32:35], v[28:31], a[96:99]
    v_mfma_f32_16x16x32_bf16 a[100:103], v[36:39], v[28:31], a[100:103]
    v_mfma_f32_16x16x32_bf16 a[104:107], v[40:43], v[28:31], a[104:107]
    v_mfma_f32_16x16x32_bf16 a[108:111], v[44:47], v[28:31], a[108:111]
    v_mfma_f32_16x16x32_bf16 a[112:115], v[48:51], v[28:31], a[112:115]
    v_mfma_f32_16x16x32_bf16 a[116:119], v[52:55], v[28:31], a[116:119]
    v_mfma_f32_16x16x32_bf16 a[120:123], v[56:59], v[28:31], a[120:123]
    v_mfma_f32_16x16x32_bf16 a[124:127], v[60:63], v[28:31], a[124:127]
    s_mov_b32 s31, 4096
    buffer_load_dwordx4 v[16:19], v7, s[12:15], s31 offen
    buffer_load_dwordx4 v[20:23], v10, s[12:15], s31 offen
    buffer_load_dwordx4 v[24:27], v11, s[12:15], s31 offen
    buffer_load_dwordx4 v[28:31], v12, s[12:15], s31 offen
    buffer_load_dwordx4 v[32:35], v8, s[16:19], s31 offen
    buffer_load_dwordx4 v[36:39], v13, s[16:19], s31 offen
    buffer_load_dwordx4 v[40:43], v14, s[16:19], s31 offen
    buffer_load_dwordx4 v[44:47], v15, s[16:19], s31 offen
    buffer_load_dwordx4 v[48:51], v8, s[20:23], s31 offen
    buffer_load_dwordx4 v[52:55], v13, s[20:23], s31 offen
    buffer_load_dwordx4 v[56:59], v14, s[20:23], s31 offen
    buffer_load_dwordx4 v[60:63], v15, s[20:23], s31 offen
    s_waitcnt vmcnt(36)
    v_mfma_f32_16x16x32_bf16 a[0:3], v[80:83], v[64:67], a[0:3]
    v_mfma_f32_16x16x32_bf16 a[4:7], v[84:87], v[64:67], a[4:7]
    v_mfma_f32_16x16x32_bf16 a[8:11], v[88:91], v[64:67], a[8:11]
    v_mfma_f32_16x16x32_bf16 a[12:15], v[92:95], v[64:67], a[12:15]
    v_mfma_f32_16x16x32_bf16 a[16:19], v[96:99], v[64:67], a[16:19]
    v_mfma_f32_16x16x32_bf16 a[20:23], v[100:103], v[64:67], a[20:23]
    v_mfma_f32_16x16x32_bf16 a[24:27], v[104:107], v[64:67], a[24:27]
    v_mfma_f32_16x16x32_bf16 a[28:31], v[108:111], v[64:67], a[28:31]
    v_mfma_f32_16x16x32_bf16 a[32:35], v[80:83], v[68:71], a[32:35]
    v_mfma_f32_16x16x32_bf16 a[36:39], v[84:87], v[68:71], a[36:39]
    v_mfma_f32_16x16x32_bf16 a[40:43], v[88:91], v[68:71], a[40:43]
    v_mfma_f32_16x16x32_bf16 a[44:47], v[92:95], v[68:71], a[44:47]
    v_mfma_f32_16x16x32_bf16 a[48:51], v[96:99], v[68:71], a[48:51]
    v_mfma_f32_16x16x32_bf16 a[52:55], v[100:103], v[68:71], a[52:55]
    v_mfma_f32_16x16x32_bf16 a[56:59], v[104:107], v[68:71], a[56:59]
    v_mfma_f32_16x16x32_bf16 a[60:63], v[108:111], v[68:71], a[60:63]
    v_mfma_f32_16x16x32_bf16 a[64:67], v[80:83], v[72:75], a[64:67]
    v_mfma_f32_16x16x32_bf16 a[68:71], v[84:87], v[72:75], a[68:71]
    v_mfma_f32_16x16x32_bf16 a[72:75], v[88:91], v[72:75], a[72:75]
    v_mfma_f32_16x16x32_bf16 a[76:79], v[92:95], v[72:75], a[76:79]
    v_mfma_f32_16x16x32_bf16 a[80:83], v[96:99], v[72:75], a[80:83]
    v_mfma_f32_16x16x32_bf16 a[84:87], v[100:103], v[72:75], a[84:87]
    v_mfma_f32_16x16x32_bf16 a[88:91], v[104:107], v[72:75], a[88:91]
    v_mfma_f32_16x16x32_bf16 a[92:95], v[108:111], v[72:75], a[92:95]
    v_mfma_f32_16x16x32_bf16 a[96:99], v[80:83], v[76:79], a[96:99]
    v_mfma_f32_16x16x32_bf16 a[100:103], v[84:87], v[76:79], a[100:103]
    v_mfma_f32_16x16x32_bf16 a[104:107], v[88:91], v[76:79], a[104:107]
    v_mfma_f32_16x16x32_bf16 a[108:111], v[92:95], v[76:79], a[108:111]
    v_mfma_f32_16x16x32_bf16 a[112:115], v[96:99], v[76:79], a[112:115]
    v_mfma_f32_16x16x32_bf16 a[116:119], v[100:103], v[76:79], a[116:119]
    v_mfma_f32_16x16x32_bf16 a[120:123], v[104:107], v[76:79], a[120:123]
    v_mfma_f32_16x16x32_bf16 a[124:127], v[108:111], v[76:79], a[124:127]
    s_mov_b32 s31, 5120
    buffer_load_dwordx4 v[64:67], v7, s[12:15], s31 offen
    buffer_load_dwordx4 v[68:71], v10, s[12:15], s31 offen
    buffer_load_dwordx4 v[72:75], v11, s[12:15], s31 offen
    buffer_load_dwordx4 v[76:79], v12, s[12:15], s31 offen
    buffer_load_dwordx4 v[80:83], v8, s[16:19], s31 offen
    buffer_load_dwordx4 v[84:87], v13, s[16:19], s31 offen
    buffer_load_dwordx4 v[88:91], v14, s[16:19], s31 offen
    buffer_load_dwordx4 v[92:95], v15, s[16:19], s31 offen
    buffer_load_dwordx4 v[96:99], v8, s[20:23], s31 offen
    buffer_load_dwordx4 v[100:103], v13, s[20:23], s31 offen
    buffer_load_dwordx4 v[104:107], v14, s[20:23], s31 offen
    buffer_load_dwordx4 v[108:111], v15, s[20:23], s31 offen
    s_waitcnt vmcnt(36)
    v_mfma_f32_16x16x32_bf16 a[0:3], v[128:131], v[112:115], a[0:3]
    v_mfma_f32_16x16x32_bf16 a[4:7], v[132:135], v[112:115], a[4:7]
    v_mfma_f32_16x16x32_bf16 a[8:11], v[136:139], v[112:115], a[8:11]
    v_mfma_f32_16x16x32_bf16 a[12:15], v[140:143], v[112:115], a[12:15]
    v_mfma_f32_16x16x32_bf16 a[16:19], v[144:147], v[112:115], a[16:19]
    v_mfma_f32_16x16x32_bf16 a[20:23], v[148:151], v[112:115], a[20:23]
    v_mfma_f32_16x16x32_bf16 a[24:27], v[152:155], v[112:115], a[24:27]
    v_mfma_f32_16x16x32_bf16 a[28:31], v[156:159], v[112:115], a[28:31]
    v_mfma_f32_16x16x32_bf16 a[32:35], v[128:131], v[116:119], a[32:35]
    v_mfma_f32_16x16x32_bf16 a[36:39], v[132:135], v[116:119], a[36:39]
    v_mfma_f32_16x16x32_bf16 a[40:43], v[136:139], v[116:119], a[40:43]
    v_mfma_f32_16x16x32_bf16 a[44:47], v[140:143], v[116:119], a[44:47]
    v_mfma_f32_16x16x32_bf16 a[48:51], v[144:147], v[116:119], a[48:51]
    v_mfma_f32_16x16x32_bf16 a[52:55], v[148:151], v[116:119], a[52:55]
    v_mfma_f32_16x16x32_bf16 a[56:59], v[152:155], v[116:119], a[56:59]
    v_mfma_f32_16x16x32_bf16 a[60:63], v[156:159], v[116:119], a[60:63]
    v_mfma_f32_16x16x32_bf16 a[64:67], v[128:131], v[120:123], a[64:67]
    v_mfma_f32_16x16x32_bf16 a[68:71], v[132:135], v[120:123], a[68:71]
    v_mfma_f32_16x16x32_bf16 a[72:75], v[136:139], v[120:123], a[72:75]
    v_mfma_f32_16x16x32_bf16 a[76:79], v[140:143], v[120:123], a[76:79]
    v_mfma_f32_16x16x32_bf16 a[80:83], v[144:147], v[120:123], a[80:83]
    v_mfma_f32_16x16x32_bf16 a[84:87], v[148:151], v[120:123], a[84:87]
    v_mfma_f32_16x16x32_bf16 a[88:91], v[152:155], v[120:123], a[88:91]
    v_mfma_f32_16x16x32_bf16 a[92:95], v[156:159], v[120:123], a[92:95]
    v_mfma_f32_16x16x32_bf16 a[96:99], v[128:131], v[124:127], a[96:99]
    v_mfma_f32_16x16x32_bf16 a[100:103], v[132:135], v[124:127], a[100:103]
    v_mfma_f32_16x16x32_bf16 a[104:107], v[136:139], v[124:127], a[104:107]
    v_mfma_f32_16x16x32_bf16 a[108:111], v[140:143], v[124:127], a[108:111]
    v_mfma_f32_16x16x32_bf16 a[112:115], v[144:147], v[124:127], a[112:115]
    v_mfma_f32_16x16x32_bf16 a[116:119], v[148:151], v[124:127], a[116:119]
    v_mfma_f32_16x16x32_bf16 a[120:123], v[152:155], v[124:127], a[120:123]
    v_mfma_f32_16x16x32_bf16 a[124:127], v[156:159], v[124:127], a[124:127]
    s_mov_b32 s31, 6144
    buffer_load_dwordx4 v[112:115], v7, s[12:15], s31 offen
    buffer_load_dwordx4 v[116:119], v10, s[12:15], s31 offen
    buffer_load_dwordx4 v[120:123], v11, s[12:15], s31 offen
    buffer_load_dwordx4 v[124:127], v12, s[12:15], s31 offen
    buffer_load_dwordx4 v[128:131], v8, s[16:19], s31 offen
    buffer_load_dwordx4 v[132:135], v13, s[16:19], s31 offen
    buffer_load_dwordx4 v[136:139], v14, s[16:19], s31 offen
    buffer_load_dwordx4 v[140:143], v15, s[16:19], s31 offen
    buffer_load_dwordx4 v[144:147], v8, s[20:23], s31 offen
    buffer_load_dwordx4 v[148:151], v13, s[20:23], s31 offen
    buffer_load_dwordx4 v[152:155], v14, s[20:23], s31 offen
    buffer_load_dwordx4 v[156:159], v15, s[20:23], s31 offen
    s_waitcnt vmcnt(36)
    v_mfma_f32_16x16x32_bf16 a[0:3], v[176:179], v[160:163], a[0:3]
    v_mfma_f32_16x16x32_bf16 a[4:7], v[180:183], v[160:163], a[4:7]
    v_mfma_f32_16x16x32_bf16 a[8:11], v[184:187], v[160:163], a[8:11]
    v_mfma_f32_16x16x32_bf16 a[12:15], v[188:191], v[160:163], a[12:15]
    v_mfma_f32_16x16x32_bf16 a[16:19], v[192:195], v[160:163], a[16:19]
    v_mfma_f32_16x16x32_bf16 a[20:23], v[196:199], v[160:163], a[20:23]
    v_mfma_f32_16x16x32_bf16 a[24:27], v[200:203], v[160:163], a[24:27]
    v_mfma_f32_16x16x32_bf16 a[28:31], v[204:207], v[160:163], a[28:31]
    v_mfma_f32_16x16x32_bf16 a[32:35], v[176:179], v[164:167], a[32:35]
    v_mfma_f32_16x16x32_bf16 a[36:39], v[180:183], v[164:167], a[36:39]
    v_mfma_f32_16x16x32_bf16 a[40:43], v[184:187], v[164:167], a[40:43]
    v_mfma_f32_16x16x32_bf16 a[44:47], v[188:191], v[164:167], a[44:47]
    v_mfma_f32_16x16x32_bf16 a[48:51], v[192:195], v[164:167], a[48:51]
    v_mfma_f32_16x16x32_bf16 a[52:55], v[196:199], v[164:167], a[52:55]
    v_mfma_f32_16x16x32_bf16 a[56:59], v[200:203], v[164:167], a[56:59]
    v_mfma_f32_16x16x32_bf16 a[60:63], v[204:207], v[164:167], a[60:63]
    v_mfma_f32_16x16x32_bf16 a[64:67], v[176:179], v[168:171], a[64:67]
    v_mfma_f32_16x16x32_bf16 a[68:71], v[180:183], v[168:171], a[68:71]
    v_mfma_f32_16x16x32_bf16 a[72:75], v[184:187], v[168:171], a[72:75]
    v_mfma_f32_16x16x32_bf16 a[76:79], v[188:191], v[168:171], a[76:79]
    v_mfma_f32_16x16x32_bf16 a[80:83], v[192:195], v[168:171], a[80:83]
    v_mfma_f32_16x16x32_bf16 a[84:87], v[196:199], v[168:171], a[84:87]
    v_mfma_f32_16x16x32_bf16 a[88:91], v[200:203], v[168:171], a[88:91]
    v_mfma_f32_16x16x32_bf16 a[92:95], v[204:207], v[168:171], a[92:95]
    v_mfma_f32_16x16x32_bf16 a[96:99], v[176:179], v[172:175], a[96:99]
    v_mfma_f32_16x16x32_bf16 a[100:103], v[180:183], v[172:175], a[100:103]
    v_mfma_f32_16x16x32_bf16 a[104:107], v[184:187], v[172:175], a[104:107]
    v_mfma_f32_16x16x32_bf16 a[108:111], v[188:191], v[172:175], a[108:111]
    v_mfma_f32_16x16x32_bf16 a[112:115], v[192:195], v[172:175], a[112:115]
    v_mfma_f32_16x16x32_bf16 a[116:119], v[196:199], v[172:175], a[116:119]
    v_mfma_f32_16x16x32_bf16 a[120:123], v[200:203], v[172:175], a[120:123]
    v_mfma_f32_16x16x32_bf16 a[124:127], v[204:207], v[172:175], a[124:127]
    s_mov_b32 s31, 7168
    buffer_load_dwordx4 v[160:163], v7, s[12:15], s31 offen
    buffer_load_dwordx4 v[164:167], v10, s[12:15], s31 offen
    buffer_load_dwordx4 v[168:171], v11, s[12:15], s31 offen
    buffer_load_dwordx4 v[172:175], v12, s[12:15], s31 offen
    buffer_load_dwordx4 v[176:179], v8, s[16:19], s31 offen
    buffer_load_dwordx4 v[180:183], v13, s[16:19], s31 offen
    buffer_load_dwordx4 v[184:187], v14, s[16:19], s31 offen
    buffer_load_dwordx4 v[188:191], v15, s[16:19], s31 offen
    buffer_load_dwordx4 v[192:195], v8, s[20:23], s31 offen
    buffer_load_dwordx4 v[196:199], v13, s[20:23], s31 offen
    buffer_load_dwordx4 v[200:203], v14, s[20:23], s31 offen
    buffer_load_dwordx4 v[204:207], v15, s[20:23], s31 offen
    s_waitcnt vmcnt(36)
    v_mfma_f32_16x16x32_bf16 a[0:3], v[32:35], v[16:19], a[0:3]
    v_mfma_f32_16x16x32_bf16 a[4:7], v[36:39], v[16:19], a[4:7]
    v_mfma_f32_16x16x32_bf16 a[8:11], v[40:43], v[16:19], a[8:11]
    v_mfma_f32_16x16x32_bf16 a[12:15], v[44:47], v[16:19], a[12:15]
    v_mfma_f32_16x16x32_bf16 a[16:19], v[48:51], v[16:19], a[16:19]
    v_mfma_f32_16x16x32_bf16 a[20:23], v[52:55], v[16:19], a[20:23]
    v_mfma_f32_16x16x32_bf16 a[24:27], v[56:59], v[16:19], a[24:27]
    v_mfma_f32_16x16x32_bf16 a[28:31], v[60:63], v[16:19], a[28:31]
    v_mfma_f32_16x16x32_bf16 a[32:35], v[32:35], v[20:23], a[32:35]
    v_mfma_f32_16x16x32_bf16 a[36:39], v[36:39], v[20:23], a[36:39]
    v_mfma_f32_16x16x32_bf16 a[40:43], v[40:43], v[20:23], a[40:43]
    v_mfma_f32_16x16x32_bf16 a[44:47], v[44:47], v[20:23], a[44:47]
    v_mfma_f32_16x16x32_bf16 a[48:51], v[48:51], v[20:23], a[48:51]
    v_mfma_f32_16x16x32_bf16 a[52:55], v[52:55], v[20:23], a[52:55]
    v_mfma_f32_16x16x32_bf16 a[56:59], v[56:59], v[20:23], a[56:59]
    v_mfma_f32_16x16x32_bf16 a[60:63], v[60:63], v[20:23], a[60:63]
    v_mfma_f32_16x16x32_bf16 a[64:67], v[32:35], v[24:27], a[64:67]
    v_mfma_f32_16x16x32_bf16 a[68:71], v[36:39], v[24:27], a[68:71]
    v_mfma_f32_16x16x32_bf16 a[72:75], v[40:43], v[24:27], a[72:75]
    v_mfma_f32_16x16x32_bf16 a[76:79], v[44:47], v[24:27], a[76:79]
    v_mfma_f32_16x16x32_bf16 a[80:83], v[48:51], v[24:27], a[80:83]
    v_mfma_f32_16x16x32_bf16 a[84:87], v[52:55], v[24:27], a[84:87]
    v_mfma_f32_16x16x32_bf16 a[88:91], v[56:59], v[24:27], a[88:91]
    v_mfma_f32_16x16x32_bf16 a[92:95], v[60:63], v[24:27], a[92:95]
    v_mfma_f32_16x16x32_bf16 a[96:99], v[32:35], v[28:31], a[96:99]
    v_mfma_f32_16x16x32_bf16 a[100:103], v[36:39], v[28:31], a[100:103]
    v_mfma_f32_16x16x32_bf16 a[104:107], v[40:43], v[28:31], a[104:107]
    v_mfma_f32_16x16x32_bf16 a[108:111], v[44:47], v[28:31], a[108:111]
    v_mfma_f32_16x16x32_bf16 a[112:115], v[48:51], v[28:31], a[112:115]
    v_mfma_f32_16x16x32_bf16 a[116:119], v[52:55], v[28:31], a[116:119]
    v_mfma_f32_16x16x32_bf16 a[120:123], v[56:59], v[28:31], a[120:123]
    v_mfma_f32_16x16x32_bf16 a[124:127], v[60:63], v[28:31], a[124:127]
    s_mov_b32 s31, 8192
    buffer_load_dwordx4 v[16:19], v7, s[12:15], s31 offen
    buffer_load_dwordx4 v[20:23], v10, s[12:15], s31 offen
    buffer_load_dwordx4 v[24:27], v11, s[12:15], s31 offen
    buffer_load_dwordx4 v[28:31], v12, s[12:15], s31 offen
    buffer_load_dwordx4 v[32:35], v8, s[16:19], s31 offen
    buffer_load_dwordx4 v[36:39], v13, s[16:19], s31 offen
    buffer_load_dwordx4 v[40:43], v14, s[16:19], s31 offen
    buffer_load_dwordx4 v[44:47], v15, s[16:19], s31 offen
    buffer_load_dwordx4 v[48:51], v8, s[20:23], s31 offen
    buffer_load_dwordx4 v[52:55], v13, s[20:23], s31 offen
    buffer_load_dwordx4 v[56:59], v14, s[20:23], s31 offen
    buffer_load_dwordx4 v[60:63], v15, s[20:23], s31 offen
    s_waitcnt vmcnt(36)
    v_mfma_f32_16x16x32_bf16 a[0:3], v[80:83], v[64:67], a[0:3]
    v_mfma_f32_16x16x32_bf16 a[4:7], v[84:87], v[64:67], a[4:7]
    v_mfma_f32_16x16x32_bf16 a[8:11], v[88:91], v[64:67], a[8:11]
    v_mfma_f32_16x16x32_bf16 a[12:15], v[92:95], v[64:67], a[12:15]
    v_mfma_f32_16x16x32_bf16 a[16:19], v[96:99], v[64:67], a[16:19]
    v_mfma_f32_16x16x32_bf16 a[20:23], v[100:103], v[64:67], a[20:23]
    v_mfma_f32_16x16x32_bf16 a[24:27], v[104:107], v[64:67], a[24:27]
    v_mfma_f32_16x16x32_bf16 a[28:31], v[108:111], v[64:67], a[28:31]
    v_mfma_f32_16x16x32_bf16 a[32:35], v[80:83], v[68:71], a[32:35]
    v_mfma_f32_16x16x32_bf16 a[36:39], v[84:87], v[68:71], a[36:39]
    v_mfma_f32_16x16x32_bf16 a[40:43], v[88:91], v[68:71], a[40:43]
    v_mfma_f32_16x16x32_bf16 a[44:47], v[92:95], v[68:71], a[44:47]
    v_mfma_f32_16x16x32_bf16 a[48:51], v[96:99], v[68:71], a[48:51]
    v_mfma_f32_16x16x32_bf16 a[52:55], v[100:103], v[68:71], a[52:55]
    v_mfma_f32_16x16x32_bf16 a[56:59], v[104:107], v[68:71], a[56:59]
    v_mfma_f32_16x16x32_bf16 a[60:63], v[108:111], v[68:71], a[60:63]
    v_mfma_f32_16x16x32_bf16 a[64:67], v[80:83], v[72:75], a[64:67]
    v_mfma_f32_16x16x32_bf16 a[68:71], v[84:87], v[72:75], a[68:71]
    v_mfma_f32_16x16x32_bf16 a[72:75], v[88:91], v[72:75], a[72:75]
    v_mfma_f32_16x16x32_bf16 a[76:79], v[92:95], v[72:75], a[76:79]
    v_mfma_f32_16x16x32_bf16 a[80:83], v[96:99], v[72:75], a[80:83]
    v_mfma_f32_16x16x32_bf16 a[84:87], v[100:103], v[72:75], a[84:87]
    v_mfma_f32_16x16x32_bf16 a[88:91], v[104:107], v[72:75], a[88:91]
    v_mfma_f32_16x16x32_bf16 a[92:95], v[108:111], v[72:75], a[92:95]
    v_mfma_f32_16x16x32_bf16 a[96:99], v[80:83], v[76:79], a[96:99]
    v_mfma_f32_16x16x32_bf16 a[100:103], v[84:87], v[76:79], a[100:103]
    v_mfma_f32_16x16x32_bf16 a[104:107], v[88:91], v[76:79], a[104:107]
    v_mfma_f32_16x16x32_bf16 a[108:111], v[92:95], v[76:79], a[108:111]
    v_mfma_f32_16x16x32_bf16 a[112:115], v[96:99], v[76:79], a[112:115]
    v_mfma_f32_16x16x32_bf16 a[116:119], v[100:103], v[76:79], a[116:119]
    v_mfma_f32_16x16x32_bf16 a[120:123], v[104:107], v[76:79], a[120:123]
    v_mfma_f32_16x16x32_bf16 a[124:127], v[108:111], v[76:79], a[124:127]
    s_mov_b32 s31, 9216
    buffer_load_dwordx4 v[64:67], v7, s[12:15], s31 offen
    buffer_load_dwordx4 v[68:71], v10, s[12:15], s31 offen
    buffer_load_dwordx4 v[72:75], v11, s[12:15], s31 offen
    buffer_load_dwordx4 v[76:79], v12, s[12:15], s31 offen
    buffer_load_dwordx4 v[80:83], v8, s[16:19], s31 offen
    buffer_load_dwordx4 v[84:87], v13, s[16:19], s31 offen
    buffer_load_dwordx4 v[88:91], v14, s[16:19], s31 offen
    buffer_load_dwordx4 v[92:95], v15, s[16:19], s31 offen
    buffer_load_dwordx4 v[96:99], v8, s[20:23], s31 offen
    buffer_load_dwordx4 v[100:103], v13, s[20:23], s31 offen
    buffer_load_dwordx4 v[104:107], v14, s[20:23], s31 offen
    buffer_load_dwordx4 v[108:111], v15, s[20:23], s31 offen
    s_waitcnt vmcnt(36)
    v_mfma_f32_16x16x32_bf16 a[0:3], v[128:131], v[112:115], a[0:3]
    v_mfma_f32_16x16x32_bf16 a[4:7], v[132:135], v[112:115], a[4:7]
    v_mfma_f32_16x16x32_bf16 a[8:11], v[136:139], v[112:115], a[8:11]
    v_mfma_f32_16x16x32_bf16 a[12:15], v[140:143], v[112:115], a[12:15]
    v_mfma_f32_16x16x32_bf16 a[16:19], v[144:147], v[112:115], a[16:19]
    v_mfma_f32_16x16x32_bf16 a[20:23], v[148:151], v[112:115], a[20:23]
    v_mfma_f32_16x16x32_bf16 a[24:27], v[152:155], v[112:115], a[24:27]
    v_mfma_f32_16x16x32_bf16 a[28:31], v[156:159], v[112:115], a[28:31]
    v_mfma_f32_16x16x32_bf16 a[32:35], v[128:131], v[116:119], a[32:35]
    v_mfma_f32_16x16x32_bf16 a[36:39], v[132:135], v[116:119], a[36:39]
    v_mfma_f32_16x16x32_bf16 a[40:43], v[136:139], v[116:119], a[40:43]
    v_mfma_f32_16x16x32_bf16 a[44:47], v[140:143], v[116:119], a[44:47]
    v_mfma_f32_16x16x32_bf16 a[48:51], v[144:147], v[116:119], a[48:51]
    v_mfma_f32_16x16x32_bf16 a[52:55], v[148:151], v[116:119], a[52:55]
    v_mfma_f32_16x16x32_bf16 a[56:59], v[152:155], v[116:119], a[56:59]
    v_mfma_f32_16x16x32_bf16 a[60:63], v[156:159], v[116:119], a[60:63]
    v_mfma_f32_16x16x32_bf16 a[64:67], v[128:131], v[120:123], a[64:67]
    v_mfma_f32_16x16x32_bf16 a[68:71], v[132:135], v[120:123], a[68:71]
    v_mfma_f32_16x16x32_bf16 a[72:75], v[136:139], v[120:123], a[72:75]
    v_mfma_f32_16x16x32_bf16 a[76:79], v[140:143], v[120:123], a[76:79]
    v_mfma_f32_16x16x32_bf16 a[80:83], v[144:147], v[120:123], a[80:83]
    v_mfma_f32_16x16x32_bf16 a[84:87], v[148:151], v[120:123], a[84:87]
    v_mfma_f32_16x16x32_bf16 a[88:91], v[152:155], v[120:123], a[88:91]
    v_mfma_f32_16x16x32_bf16 a[92:95], v[156:159], v[120:123], a[92:95]
    v_mfma_f32_16x16x32_bf16 a[96:99], v[128:131], v[124:127], a[96:99]
    v_mfma_f32_16x16x32_bf16 a[100:103], v[132:135], v[124:127], a[100:103]
    v_mfma_f32_16x16x32_bf16 a[104:107], v[136:139], v[124:127], a[104:107]
    v_mfma_f32_16x16x32_bf16 a[108:111], v[140:143], v[124:127], a[108:111]
    v_mfma_f32_16x16x32_bf16 a[112:115], v[144:147], v[124:127], a[112:115]
    v_mfma_f32_16x16x32_bf16 a[116:119], v[148:151], v[124:127], a[116:119]
    v_mfma_f32_16x16x32_bf16 a[120:123], v[152:155], v[124:127], a[120:123]
    v_mfma_f32_16x16x32_bf16 a[124:127], v[156:159], v[124:127], a[124:127]
    s_mov_b32 s31, 10240
    buffer_load_dwordx4 v[112:115], v7, s[12:15], s31 offen
    buffer_load_dwordx4 v[116:119], v10, s[12:15], s31 offen
    buffer_load_dwordx4 v[120:123], v11, s[12:15], s31 offen
    buffer_load_dwordx4 v[124:127], v12, s[12:15], s31 offen
    buffer_load_dwordx4 v[128:131], v8, s[16:19], s31 offen
    buffer_load_dwordx4 v[132:135], v13, s[16:19], s31 offen
    buffer_load_dwordx4 v[136:139], v14, s[16:19], s31 offen
    buffer_load_dwordx4 v[140:143], v15, s[16:19], s31 offen
    buffer_load_dwordx4 v[144:147], v8, s[20:23], s31 offen
    buffer_load_dwordx4 v[148:151], v13, s[20:23], s31 offen
    buffer_load_dwordx4 v[152:155], v14, s[20:23], s31 offen
    buffer_load_dwordx4 v[156:159], v15, s[20:23], s31 offen
    s_waitcnt vmcnt(36)
    v_mfma_f32_16x16x32_bf16 a[0:3], v[176:179], v[160:163], a[0:3]
    v_mfma_f32_16x16x32_bf16 a[4:7], v[180:183], v[160:163], a[4:7]
    v_mfma_f32_16x16x32_bf16 a[8:11], v[184:187], v[160:163], a[8:11]
    v_mfma_f32_16x16x32_bf16 a[12:15], v[188:191], v[160:163], a[12:15]
    v_mfma_f32_16x16x32_bf16 a[16:19], v[192:195], v[160:163], a[16:19]
    v_mfma_f32_16x16x32_bf16 a[20:23], v[196:199], v[160:163], a[20:23]
    v_mfma_f32_16x16x32_bf16 a[24:27], v[200:203], v[160:163], a[24:27]
    v_mfma_f32_16x16x32_bf16 a[28:31], v[204:207], v[160:163], a[28:31]
    v_mfma_f32_16x16x32_bf16 a[32:35], v[176:179], v[164:167], a[32:35]
    v_mfma_f32_16x16x32_bf16 a[36:39], v[180:183], v[164:167], a[36:39]
    v_mfma_f32_16x16x32_bf16 a[40:43], v[184:187], v[164:167], a[40:43]
    v_mfma_f32_16x16x32_bf16 a[44:47], v[188:191], v[164:167], a[44:47]
    v_mfma_f32_16x16x32_bf16 a[48:51], v[192:195], v[164:167], a[48:51]
    v_mfma_f32_16x16x32_bf16 a[52:55], v[196:199], v[164:167], a[52:55]
    v_mfma_f32_16x16x32_bf16 a[56:59], v[200:203], v[164:167], a[56:59]
    v_mfma_f32_16x16x32_bf16 a[60:63], v[204:207], v[164:167], a[60:63]
    v_mfma_f32_16x16x32_bf16 a[64:67], v[176:179], v[168:171], a[64:67]
    v_mfma_f32_16x16x32_bf16 a[68:71], v[180:183], v[168:171], a[68:71]
    v_mfma_f32_16x16x32_bf16 a[72:75], v[184:187], v[168:171], a[72:75]
    v_mfma_f32_16x16x32_bf16 a[76:79], v[188:191], v[168:171], a[76:79]
    v_mfma_f32_16x16x32_bf16 a[80:83], v[192:195], v[168:171], a[80:83]
    v_mfma_f32_16x16x32_bf16 a[84:87], v[196:199], v[168:171], a[84:87]
    v_mfma_f32_16x16x32_bf16 a[88:91], v[200:203], v[168:171], a[88:91]
    v_mfma_f32_16x16x32_bf16 a[92:95], v[204:207], v[168:171], a[92:95]
    v_mfma_f32_16x16x32_bf16 a[96:99], v[176:179], v[172:175], a[96:99]
    v_mfma_f32_16x16x32_bf16 a[100:103], v[180:183], v[172:175], a[100:103]
    v_mfma_f32_16x16x32_bf16 a[104:107], v[184:187], v[172:175], a[104:107]
    v_mfma_f32_16x16x32_bf16 a[108:111], v[188:191], v[172:175], a[108:111]
    v_mfma_f32_16x16x32_bf16 a[112:115], v[192:195], v[172:175], a[112:115]
    v_mfma_f32_16x16x32_bf16 a[116:119], v[196:199], v[172:175], a[116:119]
    v_mfma_f32_16x16x32_bf16 a[120:123], v[200:203], v[172:175], a[120:123]
    v_mfma_f32_16x16x32_bf16 a[124:127], v[204:207], v[172:175], a[124:127]
    s_mov_b32 s31, 11264
    buffer_load_dwordx4 v[160:163], v7, s[12:15], s31 offen
    buffer_load_dwordx4 v[164:167], v10, s[12:15], s31 offen
    buffer_load_dwordx4 v[168:171], v11, s[12:15], s31 offen
    buffer_load_dwordx4 v[172:175], v12, s[12:15], s31 offen
    buffer_load_dwordx4 v[176:179], v8, s[16:19], s31 offen
    buffer_load_dwordx4 v[180:183], v13, s[16:19], s31 offen
    buffer_load_dwordx4 v[184:187], v14, s[16:19], s31 offen
    buffer_load_dwordx4 v[188:191], v15, s[16:19], s31 offen
    buffer_load_dwordx4 v[192:195], v8, s[20:23], s31 offen
    buffer_load_dwordx4 v[196:199], v13, s[20:23], s31 offen
    buffer_load_dwordx4 v[200:203], v14, s[20:23], s31 offen
    buffer_load_dwordx4 v[204:207], v15, s[20:23], s31 offen
    s_waitcnt vmcnt(36)
    v_mfma_f32_16x16x32_bf16 a[0:3], v[32:35], v[16:19], a[0:3]
    v_mfma_f32_16x16x32_bf16 a[4:7], v[36:39], v[16:19], a[4:7]
    v_mfma_f32_16x16x32_bf16 a[8:11], v[40:43], v[16:19], a[8:11]
    v_mfma_f32_16x16x32_bf16 a[12:15], v[44:47], v[16:19], a[12:15]
    v_mfma_f32_16x16x32_bf16 a[16:19], v[48:51], v[16:19], a[16:19]
    v_mfma_f32_16x16x32_bf16 a[20:23], v[52:55], v[16:19], a[20:23]
    v_mfma_f32_16x16x32_bf16 a[24:27], v[56:59], v[16:19], a[24:27]
    v_mfma_f32_16x16x32_bf16 a[28:31], v[60:63], v[16:19], a[28:31]
    v_mfma_f32_16x16x32_bf16 a[32:35], v[32:35], v[20:23], a[32:35]
    v_mfma_f32_16x16x32_bf16 a[36:39], v[36:39], v[20:23], a[36:39]
    v_mfma_f32_16x16x32_bf16 a[40:43], v[40:43], v[20:23], a[40:43]
    v_mfma_f32_16x16x32_bf16 a[44:47], v[44:47], v[20:23], a[44:47]
    v_mfma_f32_16x16x32_bf16 a[48:51], v[48:51], v[20:23], a[48:51]
    v_mfma_f32_16x16x32_bf16 a[52:55], v[52:55], v[20:23], a[52:55]
    v_mfma_f32_16x16x32_bf16 a[56:59], v[56:59], v[20:23], a[56:59]
    v_mfma_f32_16x16x32_bf16 a[60:63], v[60:63], v[20:23], a[60:63]
    v_mfma_f32_16x16x32_bf16 a[64:67], v[32:35], v[24:27], a[64:67]
    v_mfma_f32_16x16x32_bf16 a[68:71], v[36:39], v[24:27], a[68:71]
    v_mfma_f32_16x16x32_bf16 a[72:75], v[40:43], v[24:27], a[72:75]
    v_mfma_f32_16x16x32_bf16 a[76:79], v[44:47], v[24:27], a[76:79]
    v_mfma_f32_16x16x32_bf16 a[80:83], v[48:51], v[24:27], a[80:83]
    v_mfma_f32_16x16x32_bf16 a[84:87], v[52:55], v[24:27], a[84:87]
    v_mfma_f32_16x16x32_bf16 a[88:91], v[56:59], v[24:27], a[88:91]
    v_mfma_f32_16x16x32_bf16 a[92:95], v[60:63], v[24:27], a[92:95]
    v_mfma_f32_16x16x32_bf16 a[96:99], v[32:35], v[28:31], a[96:99]
    v_mfma_f32_16x16x32_bf16 a[100:103], v[36:39], v[28:31], a[100:103]
    v_mfma_f32_16x16x32_bf16 a[104:107], v[40:43], v[28:31], a[104:107]
    v_mfma_f32_16x16x32_bf16 a[108:111], v[44:47], v[28:31], a[108:111]
    v_mfma_f32_16x16x32_bf16 a[112:115], v[48:51], v[28:31], a[112:115]
    v_mfma_f32_16x16x32_bf16 a[116:119], v[52:55], v[28:31], a[116:119]
    v_mfma_f32_16x16x32_bf16 a[120:123], v[56:59], v[28:31], a[120:123]
    v_mfma_f32_16x16x32_bf16 a[124:127], v[60:63], v[28:31], a[124:127]
    s_mov_b32 s31, 12288
    buffer_load_dwordx4 v[16:19], v7, s[12:15], s31 offen
    buffer_load_dwordx4 v[20:23], v10, s[12:15], s31 offen
    buffer_load_dwordx4 v[24:27], v11, s[12:15], s31 offen
    buffer_load_dwordx4 v[28:31], v12, s[12:15], s31 offen
    buffer_load_dwordx4 v[32:35], v8, s[16:19], s31 offen
    buffer_load_dwordx4 v[36:39], v13, s[16:19], s31 offen
    buffer_load_dwordx4 v[40:43], v14, s[16:19], s31 offen
    buffer_load_dwordx4 v[44:47], v15, s[16:19], s31 offen
    buffer_load_dwordx4 v[48:51], v8, s[20:23], s31 offen
    buffer_load_dwordx4 v[52:55], v13, s[20:23], s31 offen
    buffer_load_dwordx4 v[56:59], v14, s[20:23], s31 offen
    buffer_load_dwordx4 v[60:63], v15, s[20:23], s31 offen
    s_waitcnt vmcnt(36)
    v_mfma_f32_16x16x32_bf16 a[0:3], v[80:83], v[64:67], a[0:3]
    v_mfma_f32_16x16x32_bf16 a[4:7], v[84:87], v[64:67], a[4:7]
    v_mfma_f32_16x16x32_bf16 a[8:11], v[88:91], v[64:67], a[8:11]
    v_mfma_f32_16x16x32_bf16 a[12:15], v[92:95], v[64:67], a[12:15]
    v_mfma_f32_16x16x32_bf16 a[16:19], v[96:99], v[64:67], a[16:19]
    v_mfma_f32_16x16x32_bf16 a[20:23], v[100:103], v[64:67], a[20:23]
    v_mfma_f32_16x16x32_bf16 a[24:27], v[104:107], v[64:67], a[24:27]
    v_mfma_f32_16x16x32_bf16 a[28:31], v[108:111], v[64:67], a[28:31]
    v_mfma_f32_16x16x32_bf16 a[32:35], v[80:83], v[68:71], a[32:35]
    v_mfma_f32_16x16x32_bf16 a[36:39], v[84:87], v[68:71], a[36:39]
    v_mfma_f32_16x16x32_bf16 a[40:43], v[88:91], v[68:71], a[40:43]
    v_mfma_f32_16x16x32_bf16 a[44:47], v[92:95], v[68:71], a[44:47]
    v_mfma_f32_16x16x32_bf16 a[48:51], v[96:99], v[68:71], a[48:51]
    v_mfma_f32_16x16x32_bf16 a[52:55], v[100:103], v[68:71], a[52:55]
    v_mfma_f32_16x16x32_bf16 a[56:59], v[104:107], v[68:71], a[56:59]
    v_mfma_f32_16x16x32_bf16 a[60:63], v[108:111], v[68:71], a[60:63]
    v_mfma_f32_16x16x32_bf16 a[64:67], v[80:83], v[72:75], a[64:67]
    v_mfma_f32_16x16x32_bf16 a[68:71], v[84:87], v[72:75], a[68:71]
    v_mfma_f32_16x16x32_bf16 a[72:75], v[88:91], v[72:75], a[72:75]
    v_mfma_f32_16x16x32_bf16 a[76:79], v[92:95], v[72:75], a[76:79]
    v_mfma_f32_16x16x32_bf16 a[80:83], v[96:99], v[72:75], a[80:83]
    v_mfma_f32_16x16x32_bf16 a[84:87], v[100:103], v[72:75], a[84:87]
    v_mfma_f32_16x16x32_bf16 a[88:91], v[104:107], v[72:75], a[88:91]
    v_mfma_f32_16x16x32_bf16 a[92:95], v[108:111], v[72:75], a[92:95]
    v_mfma_f32_16x16x32_bf16 a[96:99], v[80:83], v[76:79], a[96:99]
    v_mfma_f32_16x16x32_bf16 a[100:103], v[84:87], v[76:79], a[100:103]
    v_mfma_f32_16x16x32_bf16 a[104:107], v[88:91], v[76:79], a[104:107]
    v_mfma_f32_16x16x32_bf16 a[108:111], v[92:95], v[76:79], a[108:111]
    v_mfma_f32_16x16x32_bf16 a[112:115], v[96:99], v[76:79], a[112:115]
    v_mfma_f32_16x16x32_bf16 a[116:119], v[100:103], v[76:79], a[116:119]
    v_mfma_f32_16x16x32_bf16 a[120:123], v[104:107], v[76:79], a[120:123]
    v_mfma_f32_16x16x32_bf16 a[124:127], v[108:111], v[76:79], a[124:127]
    s_mov_b32 s31, 13312
    buffer_load_dwordx4 v[64:67], v7, s[12:15], s31 offen
    buffer_load_dwordx4 v[68:71], v10, s[12:15], s31 offen
    buffer_load_dwordx4 v[72:75], v11, s[12:15], s31 offen
    buffer_load_dwordx4 v[76:79], v12, s[12:15], s31 offen
    buffer_load_dwordx4 v[80:83], v8, s[16:19], s31 offen
    buffer_load_dwordx4 v[84:87], v13, s[16:19], s31 offen
    buffer_load_dwordx4 v[88:91], v14, s[16:19], s31 offen
    buffer_load_dwordx4 v[92:95], v15, s[16:19], s31 offen
    buffer_load_dwordx4 v[96:99], v8, s[20:23], s31 offen
    buffer_load_dwordx4 v[100:103], v13, s[20:23], s31 offen
    buffer_load_dwordx4 v[104:107], v14, s[20:23], s31 offen
    buffer_load_dwordx4 v[108:111], v15, s[20:23], s31 offen
    s_waitcnt vmcnt(36)
    v_mfma_f32_16x16x32_bf16 a[0:3], v[128:131], v[112:115], a[0:3]
    v_mfma_f32_16x16x32_bf16 a[4:7], v[132:135], v[112:115], a[4:7]
    v_mfma_f32_16x16x32_bf16 a[8:11], v[136:139], v[112:115], a[8:11]
    v_mfma_f32_16x16x32_bf16 a[12:15], v[140:143], v[112:115], a[12:15]
    v_mfma_f32_16x16x32_bf16 a[16:19], v[144:147], v[112:115], a[16:19]
    v_mfma_f32_16x16x32_bf16 a[20:23], v[148:151], v[112:115], a[20:23]
    v_mfma_f32_16x16x32_bf16 a[24:27], v[152:155], v[112:115], a[24:27]
    v_mfma_f32_16x16x32_bf16 a[28:31], v[156:159], v[112:115], a[28:31]
    v_mfma_f32_16x16x32_bf16 a[32:35], v[128:131], v[116:119], a[32:35]
    v_mfma_f32_16x16x32_bf16 a[36:39], v[132:135], v[116:119], a[36:39]
    v_mfma_f32_16x16x32_bf16 a[40:43], v[136:139], v[116:119], a[40:43]
    v_mfma_f32_16x16x32_bf16 a[44:47], v[140:143], v[116:119], a[44:47]
    v_mfma_f32_16x16x32_bf16 a[48:51], v[144:147], v[116:119], a[48:51]
    v_mfma_f32_16x16x32_bf16 a[52:55], v[148:151], v[116:119], a[52:55]
    v_mfma_f32_16x16x32_bf16 a[56:59], v[152:155], v[116:119], a[56:59]
    v_mfma_f32_16x16x32_bf16 a[60:63], v[156:159], v[116:119], a[60:63]
    v_mfma_f32_16x16x32_bf16 a[64:67], v[128:131], v[120:123], a[64:67]
    v_mfma_f32_16x16x32_bf16 a[68:71], v[132:135], v[120:123], a[68:71]
    v_mfma_f32_16x16x32_bf16 a[72:75], v[136:139], v[120:123], a[72:75]
    v_mfma_f32_16x16x32_bf16 a[76:79], v[140:143], v[120:123], a[76:79]
    v_mfma_f32_16x16x32_bf16 a[80:83], v[144:147], v[120:123], a[80:83]
    v_mfma_f32_16x16x32_bf16 a[84:87], v[148:151], v[120:123], a[84:87]
    v_mfma_f32_16x16x32_bf16 a[88:91], v[152:155], v[120:123], a[88:91]
    v_mfma_f32_16x16x32_bf16 a[92:95], v[156:159], v[120:123], a[92:95]
    v_mfma_f32_16x16x32_bf16 a[96:99], v[128:131], v[124:127], a[96:99]
    v_mfma_f32_16x16x32_bf16 a[100:103], v[132:135], v[124:127], a[100:103]
    v_mfma_f32_16x16x32_bf16 a[104:107], v[136:139], v[124:127], a[104:107]
    v_mfma_f32_16x16x32_bf16 a[108:111], v[140:143], v[124:127], a[108:111]
    v_mfma_f32_16x16x32_bf16 a[112:115], v[144:147], v[124:127], a[112:115]
    v_mfma_f32_16x16x32_bf16 a[116:119], v[148:151], v[124:127], a[116:119]
    v_mfma_f32_16x16x32_bf16 a[120:123], v[152:155], v[124:127], a[120:123]
    v_mfma_f32_16x16x32_bf16 a[124:127], v[156:159], v[124:127], a[124:127]
    s_mov_b32 s31, 14336
    buffer_load_dwordx4 v[112:115], v7, s[12:15], s31 offen
    buffer_load_dwordx4 v[116:119], v10, s[12:15], s31 offen
    buffer_load_dwordx4 v[120:123], v11, s[12:15], s31 offen
    buffer_load_dwordx4 v[124:127], v12, s[12:15], s31 offen
    buffer_load_dwordx4 v[128:131], v8, s[16:19], s31 offen
    buffer_load_dwordx4 v[132:135], v13, s[16:19], s31 offen
    buffer_load_dwordx4 v[136:139], v14, s[16:19], s31 offen
    buffer_load_dwordx4 v[140:143], v15, s[16:19], s31 offen
    buffer_load_dwordx4 v[144:147], v8, s[20:23], s31 offen
    buffer_load_dwordx4 v[148:151], v13, s[20:23], s31 offen
    buffer_load_dwordx4 v[152:155], v14, s[20:23], s31 offen
    buffer_load_dwordx4 v[156:159], v15, s[20:23], s31 offen
    s_waitcnt vmcnt(36)
    v_mfma_f32_16x16x32_bf16 a[0:3], v[176:179], v[160:163], a[0:3]
    v_mfma_f32_16x16x32_bf16 a[4:7], v[180:183], v[160:163], a[4:7]
    v_mfma_f32_16x16x32_bf16 a[8:11], v[184:187], v[160:163], a[8:11]
    v_mfma_f32_16x16x32_bf16 a[12:15], v[188:191], v[160:163], a[12:15]
    v_mfma_f32_16x16x32_bf16 a[16:19], v[192:195], v[160:163], a[16:19]
    v_mfma_f32_16x16x32_bf16 a[20:23], v[196:199], v[160:163], a[20:23]
    v_mfma_f32_16x16x32_bf16 a[24:27], v[200:203], v[160:163], a[24:27]
    v_mfma_f32_16x16x32_bf16 a[28:31], v[204:207], v[160:163], a[28:31]
    v_mfma_f32_16x16x32_bf16 a[32:35], v[176:179], v[164:167], a[32:35]
    v_mfma_f32_16x16x32_bf16 a[36:39], v[180:183], v[164:167], a[36:39]
    v_mfma_f32_16x16x32_bf16 a[40:43], v[184:187], v[164:167], a[40:43]
    v_mfma_f32_16x16x32_bf16 a[44:47], v[188:191], v[164:167], a[44:47]
    v_mfma_f32_16x16x32_bf16 a[48:51], v[192:195], v[164:167], a[48:51]
    v_mfma_f32_16x16x32_bf16 a[52:55], v[196:199], v[164:167], a[52:55]
    v_mfma_f32_16x16x32_bf16 a[56:59], v[200:203], v[164:167], a[56:59]
    v_mfma_f32_16x16x32_bf16 a[60:63], v[204:207], v[164:167], a[60:63]
    v_mfma_f32_16x16x32_bf16 a[64:67], v[176:179], v[168:171], a[64:67]
    v_mfma_f32_16x16x32_bf16 a[68:71], v[180:183], v[168:171], a[68:71]
    v_mfma_f32_16x16x32_bf16 a[72:75], v[184:187], v[168:171], a[72:75]
    v_mfma_f32_16x16x32_bf16 a[76:79], v[188:191], v[168:171], a[76:79]
    v_mfma_f32_16x16x32_bf16 a[80:83], v[192:195], v[168:171], a[80:83]
    v_mfma_f32_16x16x32_bf16 a[84:87], v[196:199], v[168:171], a[84:87]
    v_mfma_f32_16x16x32_bf16 a[88:91], v[200:203], v[168:171], a[88:91]
    v_mfma_f32_16x16x32_bf16 a[92:95], v[204:207], v[168:171], a[92:95]
    v_mfma_f32_16x16x32_bf16 a[96:99], v[176:179], v[172:175], a[96:99]
    v_mfma_f32_16x16x32_bf16 a[100:103], v[180:183], v[172:175], a[100:103]
    v_mfma_f32_16x16x32_bf16 a[104:107], v[184:187], v[172:175], a[104:107]
    v_mfma_f32_16x16x32_bf16 a[108:111], v[188:191], v[172:175], a[108:111]
    v_mfma_f32_16x16x32_bf16 a[112:115], v[192:195], v[172:175], a[112:115]
    v_mfma_f32_16x16x32_bf16 a[116:119], v[196:199], v[172:175], a[116:119]
    v_mfma_f32_16x16x32_bf16 a[120:123], v[200:203], v[172:175], a[120:123]
    v_mfma_f32_16x16x32_bf16 a[124:127], v[204:207], v[172:175], a[124:127]
    s_mov_b32 s31, 15360
    buffer_load_dwordx4 v[160:163], v7, s[12:15], s31 offen
    buffer_load_dwordx4 v[164:167], v10, s[12:15], s31 offen
    buffer_load_dwordx4 v[168:171], v11, s[12:15], s31 offen
    buffer_load_dwordx4 v[172:175], v12, s[12:15], s31 offen
    buffer_load_dwordx4 v[176:179], v8, s[16:19], s31 offen
    buffer_load_dwordx4 v[180:183], v13, s[16:19], s31 offen
    buffer_load_dwordx4 v[184:187], v14, s[16:19], s31 offen
    buffer_load_dwordx4 v[188:191], v15, s[16:19], s31 offen
    buffer_load_dwordx4 v[192:195], v8, s[20:23], s31 offen
    buffer_load_dwordx4 v[196:199], v13, s[20:23], s31 offen
    buffer_load_dwordx4 v[200:203], v14, s[20:23], s31 offen
    buffer_load_dwordx4 v[204:207], v15, s[20:23], s31 offen
    s_waitcnt vmcnt(36)
    v_mfma_f32_16x16x32_bf16 a[0:3], v[32:35], v[16:19], a[0:3]
    v_mfma_f32_16x16x32_bf16 a[4:7], v[36:39], v[16:19], a[4:7]
    v_mfma_f32_16x16x32_bf16 a[8:11], v[40:43], v[16:19], a[8:11]
    v_mfma_f32_16x16x32_bf16 a[12:15], v[44:47], v[16:19], a[12:15]
    v_mfma_f32_16x16x32_bf16 a[16:19], v[48:51], v[16:19], a[16:19]
    v_mfma_f32_16x16x32_bf16 a[20:23], v[52:55], v[16:19], a[20:23]
    v_mfma_f32_16x16x32_bf16 a[24:27], v[56:59], v[16:19], a[24:27]
    v_mfma_f32_16x16x32_bf16 a[28:31], v[60:63], v[16:19], a[28:31]
    v_mfma_f32_16x16x32_bf16 a[32:35], v[32:35], v[20:23], a[32:35]
    v_mfma_f32_16x16x32_bf16 a[36:39], v[36:39], v[20:23], a[36:39]
    v_mfma_f32_16x16x32_bf16 a[40:43], v[40:43], v[20:23], a[40:43]
    v_mfma_f32_16x16x32_bf16 a[44:47], v[44:47], v[20:23], a[44:47]
    v_mfma_f32_16x16x32_bf16 a[48:51], v[48:51], v[20:23], a[48:51]
    v_mfma_f32_16x16x32_bf16 a[52:55], v[52:55], v[20:23], a[52:55]
    v_mfma_f32_16x16x32_bf16 a[56:59], v[56:59], v[20:23], a[56:59]
    v_mfma_f32_16x16x32_bf16 a[60:63], v[60:63], v[20:23], a[60:63]
    v_mfma_f32_16x16x32_bf16 a[64:67], v[32:35], v[24:27], a[64:67]
    v_mfma_f32_16x16x32_bf16 a[68:71], v[36:39], v[24:27], a[68:71]
    v_mfma_f32_16x16x32_bf16 a[72:75], v[40:43], v[24:27], a[72:75]
    v_mfma_f32_16x16x32_bf16 a[76:79], v[44:47], v[24:27], a[76:79]
    v_mfma_f32_16x16x32_bf16 a[80:83], v[48:51], v[24:27], a[80:83]
    v_mfma_f32_16x16x32_bf16 a[84:87], v[52:55], v[24:27], a[84:87]
    v_mfma_f32_16x16x32_bf16 a[88:91], v[56:59], v[24:27], a[88:91]
    v_mfma_f32_16x16x32_bf16 a[92:95], v[60:63], v[24:27], a[92:95]
    v_mfma_f32_16x16x32_bf16 a[96:99], v[32:35], v[28:31], a[96:99]
    v_mfma_f32_16x16x32_bf16 a[100:103], v[36:39], v[28:31], a[100:103]
    v_mfma_f32_16x16x32_bf16 a[104:107], v[40:43], v[28:31], a[104:107]
    v_mfma_f32_16x16x32_bf16 a[108:111], v[44:47], v[28:31], a[108:111]
    v_mfma_f32_16x16x32_bf16 a[112:115], v[48:51], v[28:31], a[112:115]
    v_mfma_f32_16x16x32_bf16 a[116:119], v[52:55], v[28:31], a[116:119]
    v_mfma_f32_16x16x32_bf16 a[120:123], v[56:59], v[28:31], a[120:123]
    v_mfma_f32_16x16x32_bf16 a[124:127], v[60:63], v[28:31], a[124:127]
    s_waitcnt vmcnt(24)
    v_mfma_f32_16x16x32_bf16 a[0:3], v[80:83], v[64:67], a[0:3]
    v_mfma_f32_16x16x32_bf16 a[4:7], v[84:87], v[64:67], a[4:7]
    v_mfma_f32_16x16x32_bf16 a[8:11], v[88:91], v[64:67], a[8:11]
    v_mfma_f32_16x16x32_bf16 a[12:15], v[92:95], v[64:67], a[12:15]
    v_mfma_f32_16x16x32_bf16 a[16:19], v[96:99], v[64:67], a[16:19]
    v_mfma_f32_16x16x32_bf16 a[20:23], v[100:103], v[64:67], a[20:23]
    v_mfma_f32_16x16x32_bf16 a[24:27], v[104:107], v[64:67], a[24:27]
    v_mfma_f32_16x16x32_bf16 a[28:31], v[108:111], v[64:67], a[28:31]
    v_mfma_f32_16x16x32_bf16 a[32:35], v[80:83], v[68:71], a[32:35]
    v_mfma_f32_16x16x32_bf16 a[36:39], v[84:87], v[68:71], a[36:39]
    v_mfma_f32_16x16x32_bf16 a[40:43], v[88:91], v[68:71], a[40:43]
    v_mfma_f32_16x16x32_bf16 a[44:47], v[92:95], v[68:71], a[44:47]
    v_mfma_f32_16x16x32_bf16 a[48:51], v[96:99], v[68:71], a[48:51]
    v_mfma_f32_16x16x32_bf16 a[52:55], v[100:103], v[68:71], a[52:55]
    v_mfma_f32_16x16x32_bf16 a[56:59], v[104:107], v[68:71], a[56:59]
    v_mfma_f32_16x16x32_bf16 a[60:63], v[108:111], v[68:71], a[60:63]
    v_mfma_f32_16x16x32_bf16 a[64:67], v[80:83], v[72:75], a[64:67]
    v_mfma_f32_16x16x32_bf16 a[68:71], v[84:87], v[72:75], a[68:71]
    v_mfma_f32_16x16x32_bf16 a[72:75], v[88:91], v[72:75], a[72:75]
    v_mfma_f32_16x16x32_bf16 a[76:79], v[92:95], v[72:75], a[76:79]
    v_mfma_f32_16x16x32_bf16 a[80:83], v[96:99], v[72:75], a[80:83]
    v_mfma_f32_16x16x32_bf16 a[84:87], v[100:103], v[72:75], a[84:87]
    v_mfma_f32_16x16x32_bf16 a[88:91], v[104:107], v[72:75], a[88:91]
    v_mfma_f32_16x16x32_bf16 a[92:95], v[108:111], v[72:75], a[92:95]
    v_mfma_f32_16x16x32_bf16 a[96:99], v[80:83], v[76:79], a[96:99]
    v_mfma_f32_16x16x32_bf16 a[100:103], v[84:87], v[76:79], a[100:103]
    v_mfma_f32_16x16x32_bf16 a[104:107], v[88:91], v[76:79], a[104:107]
    v_mfma_f32_16x16x32_bf16 a[108:111], v[92:95], v[76:79], a[108:111]
    v_mfma_f32_16x16x32_bf16 a[112:115], v[96:99], v[76:79], a[112:115]
    v_mfma_f32_16x16x32_bf16 a[116:119], v[100:103], v[76:79], a[116:119]
    v_mfma_f32_16x16x32_bf16 a[120:123], v[104:107], v[76:79], a[120:123]
    v_mfma_f32_16x16x32_bf16 a[124:127], v[108:111], v[76:79], a[124:127]
    s_waitcnt vmcnt(12)
    v_mfma_f32_16x16x32_bf16 a[0:3], v[128:131], v[112:115], a[0:3]
    v_mfma_f32_16x16x32_bf16 a[4:7], v[132:135], v[112:115], a[4:7]
    v_mfma_f32_16x16x32_bf16 a[8:11], v[136:139], v[112:115], a[8:11]
    v_mfma_f32_16x16x32_bf16 a[12:15], v[140:143], v[112:115], a[12:15]
    v_mfma_f32_16x16x32_bf16 a[16:19], v[144:147], v[112:115], a[16:19]
    v_mfma_f32_16x16x32_bf16 a[20:23], v[148:151], v[112:115], a[20:23]
    v_mfma_f32_16x16x32_bf16 a[24:27], v[152:155], v[112:115], a[24:27]
    v_mfma_f32_16x16x32_bf16 a[28:31], v[156:159], v[112:115], a[28:31]
    v_mfma_f32_16x16x32_bf16 a[32:35], v[128:131], v[116:119], a[32:35]
    v_mfma_f32_16x16x32_bf16 a[36:39], v[132:135], v[116:119], a[36:39]
    v_mfma_f32_16x16x32_bf16 a[40:43], v[136:139], v[116:119], a[40:43]
    v_mfma_f32_16x16x32_bf16 a[44:47], v[140:143], v[116:119], a[44:47]
    v_mfma_f32_16x16x32_bf16 a[48:51], v[144:147], v[116:119], a[48:51]
    v_mfma_f32_16x16x32_bf16 a[52:55], v[148:151], v[116:119], a[52:55]
    v_mfma_f32_16x16x32_bf16 a[56:59], v[152:155], v[116:119], a[56:59]
    v_mfma_f32_16x16x32_bf16 a[60:63], v[156:159], v[116:119], a[60:63]
    v_mfma_f32_16x16x32_bf16 a[64:67], v[128:131], v[120:123], a[64:67]
    v_mfma_f32_16x16x32_bf16 a[68:71], v[132:135], v[120:123], a[68:71]
    v_mfma_f32_16x16x32_bf16 a[72:75], v[136:139], v[120:123], a[72:75]
    v_mfma_f32_16x16x32_bf16 a[76:79], v[140:143], v[120:123], a[76:79]
    v_mfma_f32_16x16x32_bf16 a[80:83], v[144:147], v[120:123], a[80:83]
    v_mfma_f32_16x16x32_bf16 a[84:87], v[148:151], v[120:123], a[84:87]
    v_mfma_f32_16x16x32_bf16 a[88:91], v[152:155], v[120:123], a[88:91]
    v_mfma_f32_16x16x32_bf16 a[92:95], v[156:159], v[120:123], a[92:95]
    v_mfma_f32_16x16x32_bf16 a[96:99], v[128:131], v[124:127], a[96:99]
    v_mfma_f32_16x16x32_bf16 a[100:103], v[132:135], v[124:127], a[100:103]
    v_mfma_f32_16x16x32_bf16 a[104:107], v[136:139], v[124:127], a[104:107]
    v_mfma_f32_16x16x32_bf16 a[108:111], v[140:143], v[124:127], a[108:111]
    v_mfma_f32_16x16x32_bf16 a[112:115], v[144:147], v[124:127], a[112:115]
    v_mfma_f32_16x16x32_bf16 a[116:119], v[148:151], v[124:127], a[116:119]
    v_mfma_f32_16x16x32_bf16 a[120:123], v[152:155], v[124:127], a[120:123]
    v_mfma_f32_16x16x32_bf16 a[124:127], v[156:159], v[124:127], a[124:127]
    s_waitcnt vmcnt(0)
    v_mfma_f32_16x16x32_bf16 a[0:3], v[176:179], v[160:163], a[0:3]
    v_mfma_f32_16x16x32_bf16 a[4:7], v[180:183], v[160:163], a[4:7]
    v_mfma_f32_16x16x32_bf16 a[8:11], v[184:187], v[160:163], a[8:11]
    v_mfma_f32_16x16x32_bf16 a[12:15], v[188:191], v[160:163], a[12:15]
    v_mfma_f32_16x16x32_bf16 a[16:19], v[192:195], v[160:163], a[16:19]
    v_mfma_f32_16x16x32_bf16 a[20:23], v[196:199], v[160:163], a[20:23]
    v_mfma_f32_16x16x32_bf16 a[24:27], v[200:203], v[160:163], a[24:27]
    v_mfma_f32_16x16x32_bf16 a[28:31], v[204:207], v[160:163], a[28:31]
    v_mfma_f32_16x16x32_bf16 a[32:35], v[176:179], v[164:167], a[32:35]
    v_mfma_f32_16x16x32_bf16 a[36:39], v[180:183], v[164:167], a[36:39]
    v_mfma_f32_16x16x32_bf16 a[40:43], v[184:187], v[164:167], a[40:43]
    v_mfma_f32_16x16x32_bf16 a[44:47], v[188:191], v[164:167], a[44:47]
    v_mfma_f32_16x16x32_bf16 a[48:51], v[192:195], v[164:167], a[48:51]
    v_mfma_f32_16x16x32_bf16 a[52:55], v[196:199], v[164:167], a[52:55]
    v_mfma_f32_16x16x32_bf16 a[56:59], v[200:203], v[164:167], a[56:59]
    v_mfma_f32_16x16x32_bf16 a[60:63], v[204:207], v[164:167], a[60:63]
    v_mfma_f32_16x16x32_bf16 a[64:67], v[176:179], v[168:171], a[64:67]
    v_mfma_f32_16x16x32_bf16 a[68:71], v[180:183], v[168:171], a[68:71]
    v_mfma_f32_16x16x32_bf16 a[72:75], v[184:187], v[168:171], a[72:75]
    v_mfma_f32_16x16x32_bf16 a[76:79], v[188:191], v[168:171], a[76:79]
    v_mfma_f32_16x16x32_bf16 a[80:83], v[192:195], v[168:171], a[80:83]
    v_mfma_f32_16x16x32_bf16 a[84:87], v[196:199], v[168:171], a[84:87]
    v_mfma_f32_16x16x32_bf16 a[88:91], v[200:203], v[168:171], a[88:91]
    v_mfma_f32_16x16x32_bf16 a[92:95], v[204:207], v[168:171], a[92:95]
    v_mfma_f32_16x16x32_bf16 a[96:99], v[176:179], v[172:175], a[96:99]
    v_mfma_f32_16x16x32_bf16 a[100:103], v[180:183], v[172:175], a[100:103]
    v_mfma_f32_16x16x32_bf16 a[104:107], v[184:187], v[172:175], a[104:107]
    v_mfma_f32_16x16x32_bf16 a[108:111], v[188:191], v[172:175], a[108:111]
    v_mfma_f32_16x16x32_bf16 a[112:115], v[192:195], v[172:175], a[112:115]
    v_mfma_f32_16x16x32_bf16 a[116:119], v[196:199], v[172:175], a[116:119]
    v_mfma_f32_16x16x32_bf16 a[120:123], v[200:203], v[172:175], a[120:123]
    v_mfma_f32_16x16x32_bf16 a[124:127], v[204:207], v[172:175], a[124:127]
    s_nop 7
    s_nop 1
    v_mul_u32_u24 v7, 229376, v5
    v_lshl_add_u32 v7, v6, 11, v7
    v_lshl_add_u32 v7, v3, 4, v7
    v_lshrrev_b32 v8, 1, v4
    v_lshl_add_u32 v7, v8, 8, v7
    v_and_b32 v8, 1, v4
    v_lshl_add_u32 v7, v8, 3, v7
    s_mul_i32 s30, s28, 458752
    s_lshl_b32 s31, s29, 12
    s_add_u32 s30, s30, s31
    v_add_u32 v7, s30, v7
    v_accvgpr_read_b32 v20, a0
    v_accvgpr_read_b32 v24, a16
    v_accvgpr_read_b32 v21, a1
    v_accvgpr_read_b32 v25, a17
    v_accvgpr_read_b32 v22, a2
    v_accvgpr_read_b32 v26, a18
    v_accvgpr_read_b32 v23, a3
    v_accvgpr_read_b32 v27, a19
    v_cvt_pk_bf16_f32 v9, v20, v21
    v_lshlrev_b32 v20, 16, v9
    v_and_b32 v21, 0xffff0000, v9
    v_cvt_pk_bf16_f32 v9, v22, v23
    v_lshlrev_b32 v22, 16, v9
    v_and_b32 v23, 0xffff0000, v9
    v_cvt_pk_bf16_f32 v9, v24, v25
    v_lshlrev_b32 v24, 16, v9
    v_and_b32 v25, 0xffff0000, v9
    v_cvt_pk_bf16_f32 v9, v26, v27
    v_lshlrev_b32 v26, 16, v9
    v_and_b32 v27, 0xffff0000, v9
    v_max_f32 v20, 0, v20
    v_mul_f32 v20, v20, v24
    v_max_f32 v21, 0, v21
    v_mul_f32 v21, v21, v25
    v_max_f32 v22, 0, v22
    v_mul_f32 v22, v22, v26
    v_max_f32 v23, 0, v23
    v_mul_f32 v23, v23, v27
    v_cvt_pk_bf16_f32 v28, v20, v21
    v_cvt_pk_bf16_f32 v29, v22, v23
    buffer_store_dwordx2 v[28:29], v7, s[24:27], 0 offen offset:0
    v_accvgpr_read_b32 v20, a4
    v_accvgpr_read_b32 v24, a20
    v_accvgpr_read_b32 v21, a5
    v_accvgpr_read_b32 v25, a21
    v_accvgpr_read_b32 v22, a6
    v_accvgpr_read_b32 v26, a22
    v_accvgpr_read_b32 v23, a7
    v_accvgpr_read_b32 v27, a23
    v_cvt_pk_bf16_f32 v9, v20, v21
    v_lshlrev_b32 v20, 16, v9
    v_and_b32 v21, 0xffff0000, v9
    v_cvt_pk_bf16_f32 v9, v22, v23
    v_lshlrev_b32 v22, 16, v9
    v_and_b32 v23, 0xffff0000, v9
    v_cvt_pk_bf16_f32 v9, v24, v25
    v_lshlrev_b32 v24, 16, v9
    v_and_b32 v25, 0xffff0000, v9
    v_cvt_pk_bf16_f32 v9, v26, v27
    v_lshlrev_b32 v26, 16, v9
    v_and_b32 v27, 0xffff0000, v9
    v_max_f32 v20, 0, v20
    v_mul_f32 v20, v20, v24
    v_max_f32 v21, 0, v21
    v_mul_f32 v21, v21, v25
    v_max_f32 v22, 0, v22
    v_mul_f32 v22, v22, v26
    v_max_f32 v23, 0, v23
    v_mul_f32 v23, v23, v27
    v_cvt_pk_bf16_f32 v30, v20, v21
    v_cvt_pk_bf16_f32 v31, v22, v23
    buffer_store_dwordx2 v[30:31], v7, s[24:27], 0 offen offset:512
    v_accvgpr_read_b32 v20, a8
    v_accvgpr_read_b32 v24, a24
    v_accvgpr_read_b32 v21, a9
    v_accvgpr_read_b32 v25, a25
    v_accvgpr_read_b32 v22, a10
    v_accvgpr_read_b32 v26, a26
    v_accvgpr_read_b32 v23, a11
    v_accvgpr_read_b32 v27, a27
    v_cvt_pk_bf16_f32 v9, v20, v21
    v_lshlrev_b32 v20, 16, v9
    v_and_b32 v21, 0xffff0000, v9
    v_cvt_pk_bf16_f32 v9, v22, v23
    v_lshlrev_b32 v22, 16, v9
    v_and_b32 v23, 0xffff0000, v9
    v_cvt_pk_bf16_f32 v9, v24, v25
    v_lshlrev_b32 v24, 16, v9
    v_and_b32 v25, 0xffff0000, v9
    v_cvt_pk_bf16_f32 v9, v26, v27
    v_lshlrev_b32 v26, 16, v9
    v_and_b32 v27, 0xffff0000, v9
    v_max_f32 v20, 0, v20
    v_mul_f32 v20, v20, v24
    v_max_f32 v21, 0, v21
    v_mul_f32 v21, v21, v25
    v_max_f32 v22, 0, v22
    v_mul_f32 v22, v22, v26
    v_max_f32 v23, 0, v23
    v_mul_f32 v23, v23, v27
    v_cvt_pk_bf16_f32 v32, v20, v21
    v_cvt_pk_bf16_f32 v33, v22, v23
    buffer_store_dwordx2 v[32:33], v7, s[24:27], 0 offen offset:1024
    v_accvgpr_read_b32 v20, a12
    v_accvgpr_read_b32 v24, a28
    v_accvgpr_read_b32 v21, a13
    v_accvgpr_read_b32 v25, a29
    v_accvgpr_read_b32 v22, a14
    v_accvgpr_read_b32 v26, a30
    v_accvgpr_read_b32 v23, a15
    v_accvgpr_read_b32 v27, a31
    v_cvt_pk_bf16_f32 v9, v20, v21
    v_lshlrev_b32 v20, 16, v9
    v_and_b32 v21, 0xffff0000, v9
    v_cvt_pk_bf16_f32 v9, v22, v23
    v_lshlrev_b32 v22, 16, v9
    v_and_b32 v23, 0xffff0000, v9
    v_cvt_pk_bf16_f32 v9, v24, v25
    v_lshlrev_b32 v24, 16, v9
    v_and_b32 v25, 0xffff0000, v9
    v_cvt_pk_bf16_f32 v9, v26, v27
    v_lshlrev_b32 v26, 16, v9
    v_and_b32 v27, 0xffff0000, v9
    v_max_f32 v20, 0, v20
    v_mul_f32 v20, v20, v24
    v_max_f32 v21, 0, v21
    v_mul_f32 v21, v21, v25
    v_max_f32 v22, 0, v22
    v_mul_f32 v22, v22, v26
    v_max_f32 v23, 0, v23
    v_mul_f32 v23, v23, v27
    v_cvt_pk_bf16_f32 v34, v20, v21
    v_cvt_pk_bf16_f32 v35, v22, v23
    buffer_store_dwordx2 v[34:35], v7, s[24:27], 0 offen offset:1536
    v_add_u32 v7, 57344, v7
    v_accvgpr_read_b32 v20, a32
    v_accvgpr_read_b32 v24, a48
    v_accvgpr_read_b32 v21, a33
    v_accvgpr_read_b32 v25, a49
    v_accvgpr_read_b32 v22, a34
    v_accvgpr_read_b32 v26, a50
    v_accvgpr_read_b32 v23, a35
    v_accvgpr_read_b32 v27, a51
    v_cvt_pk_bf16_f32 v9, v20, v21
    v_lshlrev_b32 v20, 16, v9
    v_and_b32 v21, 0xffff0000, v9
    v_cvt_pk_bf16_f32 v9, v22, v23
    v_lshlrev_b32 v22, 16, v9
    v_and_b32 v23, 0xffff0000, v9
    v_cvt_pk_bf16_f32 v9, v24, v25
    v_lshlrev_b32 v24, 16, v9
    v_and_b32 v25, 0xffff0000, v9
    v_cvt_pk_bf16_f32 v9, v26, v27
    v_lshlrev_b32 v26, 16, v9
    v_and_b32 v27, 0xffff0000, v9
    v_max_f32 v20, 0, v20
    v_mul_f32 v20, v20, v24
    v_max_f32 v21, 0, v21
    v_mul_f32 v21, v21, v25
    v_max_f32 v22, 0, v22
    v_mul_f32 v22, v22, v26
    v_max_f32 v23, 0, v23
    v_mul_f32 v23, v23, v27
    v_cvt_pk_bf16_f32 v36, v20, v21
    v_cvt_pk_bf16_f32 v37, v22, v23
    buffer_store_dwordx2 v[36:37], v7, s[24:27], 0 offen offset:0
    v_accvgpr_read_b32 v20, a36
    v_accvgpr_read_b32 v24, a52
    v_accvgpr_read_b32 v21, a37
    v_accvgpr_read_b32 v25, a53
    v_accvgpr_read_b32 v22, a38
    v_accvgpr_read_b32 v26, a54
    v_accvgpr_read_b32 v23, a39
    v_accvgpr_read_b32 v27, a55
    v_cvt_pk_bf16_f32 v9, v20, v21
    v_lshlrev_b32 v20, 16, v9
    v_and_b32 v21, 0xffff0000, v9
    v_cvt_pk_bf16_f32 v9, v22, v23
    v_lshlrev_b32 v22, 16, v9
    v_and_b32 v23, 0xffff0000, v9
    v_cvt_pk_bf16_f32 v9, v24, v25
    v_lshlrev_b32 v24, 16, v9
    v_and_b32 v25, 0xffff0000, v9
    v_cvt_pk_bf16_f32 v9, v26, v27
    v_lshlrev_b32 v26, 16, v9
    v_and_b32 v27, 0xffff0000, v9
    v_max_f32 v20, 0, v20
    v_mul_f32 v20, v20, v24
    v_max_f32 v21, 0, v21
    v_mul_f32 v21, v21, v25
    v_max_f32 v22, 0, v22
    v_mul_f32 v22, v22, v26
    v_max_f32 v23, 0, v23
    v_mul_f32 v23, v23, v27
    v_cvt_pk_bf16_f32 v38, v20, v21
    v_cvt_pk_bf16_f32 v39, v22, v23
    buffer_store_dwordx2 v[38:39], v7, s[24:27], 0 offen offset:512
    v_accvgpr_read_b32 v20, a40
    v_accvgpr_read_b32 v24, a56
    v_accvgpr_read_b32 v21, a41
    v_accvgpr_read_b32 v25, a57
    v_accvgpr_read_b32 v22, a42
    v_accvgpr_read_b32 v26, a58
    v_accvgpr_read_b32 v23, a43
    v_accvgpr_read_b32 v27, a59
    v_cvt_pk_bf16_f32 v9, v20, v21
    v_lshlrev_b32 v20, 16, v9
    v_and_b32 v21, 0xffff0000, v9
    v_cvt_pk_bf16_f32 v9, v22, v23
    v_lshlrev_b32 v22, 16, v9
    v_and_b32 v23, 0xffff0000, v9
    v_cvt_pk_bf16_f32 v9, v24, v25
    v_lshlrev_b32 v24, 16, v9
    v_and_b32 v25, 0xffff0000, v9
    v_cvt_pk_bf16_f32 v9, v26, v27
    v_lshlrev_b32 v26, 16, v9
    v_and_b32 v27, 0xffff0000, v9
    v_max_f32 v20, 0, v20
    v_mul_f32 v20, v20, v24
    v_max_f32 v21, 0, v21
    v_mul_f32 v21, v21, v25
    v_max_f32 v22, 0, v22
    v_mul_f32 v22, v22, v26
    v_max_f32 v23, 0, v23
    v_mul_f32 v23, v23, v27
    v_cvt_pk_bf16_f32 v40, v20, v21
    v_cvt_pk_bf16_f32 v41, v22, v23
    buffer_store_dwordx2 v[40:41], v7, s[24:27], 0 offen offset:1024
    v_accvgpr_read_b32 v20, a44
    v_accvgpr_read_b32 v24, a60
    v_accvgpr_read_b32 v21, a45
    v_accvgpr_read_b32 v25, a61
    v_accvgpr_read_b32 v22, a46
    v_accvgpr_read_b32 v26, a62
    v_accvgpr_read_b32 v23, a47
    v_accvgpr_read_b32 v27, a63
    v_cvt_pk_bf16_f32 v9, v20, v21
    v_lshlrev_b32 v20, 16, v9
    v_and_b32 v21, 0xffff0000, v9
    v_cvt_pk_bf16_f32 v9, v22, v23
    v_lshlrev_b32 v22, 16, v9
    v_and_b32 v23, 0xffff0000, v9
    v_cvt_pk_bf16_f32 v9, v24, v25
    v_lshlrev_b32 v24, 16, v9
    v_and_b32 v25, 0xffff0000, v9
    v_cvt_pk_bf16_f32 v9, v26, v27
    v_lshlrev_b32 v26, 16, v9
    v_and_b32 v27, 0xffff0000, v9
    v_max_f32 v20, 0, v20
    v_mul_f32 v20, v20, v24
    v_max_f32 v21, 0, v21
    v_mul_f32 v21, v21, v25
    v_max_f32 v22, 0, v22
    v_mul_f32 v22, v22, v26
    v_max_f32 v23, 0, v23
    v_mul_f32 v23, v23, v27
    v_cvt_pk_bf16_f32 v42, v20, v21
    v_cvt_pk_bf16_f32 v43, v22, v23
    buffer_store_dwordx2 v[42:43], v7, s[24:27], 0 offen offset:1536
    v_add_u32 v7, 57344, v7
    v_accvgpr_read_b32 v20, a64
    v_accvgpr_read_b32 v24, a80
    v_accvgpr_read_b32 v21, a65
    v_accvgpr_read_b32 v25, a81
    v_accvgpr_read_b32 v22, a66
    v_accvgpr_read_b32 v26, a82
    v_accvgpr_read_b32 v23, a67
    v_accvgpr_read_b32 v27, a83
    v_cvt_pk_bf16_f32 v9, v20, v21
    v_lshlrev_b32 v20, 16, v9
    v_and_b32 v21, 0xffff0000, v9
    v_cvt_pk_bf16_f32 v9, v22, v23
    v_lshlrev_b32 v22, 16, v9
    v_and_b32 v23, 0xffff0000, v9
    v_cvt_pk_bf16_f32 v9, v24, v25
    v_lshlrev_b32 v24, 16, v9
    v_and_b32 v25, 0xffff0000, v9
    v_cvt_pk_bf16_f32 v9, v26, v27
    v_lshlrev_b32 v26, 16, v9
    v_and_b32 v27, 0xffff0000, v9
    v_max_f32 v20, 0, v20
    v_mul_f32 v20, v20, v24
    v_max_f32 v21, 0, v21
    v_mul_f32 v21, v21, v25
    v_max_f32 v22, 0, v22
    v_mul_f32 v22, v22, v26
    v_max_f32 v23, 0, v23
    v_mul_f32 v23, v23, v27
    v_cvt_pk_bf16_f32 v28, v20, v21
    v_cvt_pk_bf16_f32 v29, v22, v23
    buffer_store_dwordx2 v[28:29], v7, s[24:27], 0 offen offset:0
    v_accvgpr_read_b32 v20, a68
    v_accvgpr_read_b32 v24, a84
    v_accvgpr_read_b32 v21, a69
    v_accvgpr_read_b32 v25, a85
    v_accvgpr_read_b32 v22, a70
    v_accvgpr_read_b32 v26, a86
    v_accvgpr_read_b32 v23, a71
    v_accvgpr_read_b32 v27, a87
    v_cvt_pk_bf16_f32 v9, v20, v21
    v_lshlrev_b32 v20, 16, v9
    v_and_b32 v21, 0xffff0000, v9
    v_cvt_pk_bf16_f32 v9, v22, v23
    v_lshlrev_b32 v22, 16, v9
    v_and_b32 v23, 0xffff0000, v9
    v_cvt_pk_bf16_f32 v9, v24, v25
    v_lshlrev_b32 v24, 16, v9
    v_and_b32 v25, 0xffff0000, v9
    v_cvt_pk_bf16_f32 v9, v26, v27
    v_lshlrev_b32 v26, 16, v9
    v_and_b32 v27, 0xffff0000, v9
    v_max_f32 v20, 0, v20
    v_mul_f32 v20, v20, v24
    v_max_f32 v21, 0, v21
    v_mul_f32 v21, v21, v25
    v_max_f32 v22, 0, v22
    v_mul_f32 v22, v22, v26
    v_max_f32 v23, 0, v23
    v_mul_f32 v23, v23, v27
    v_cvt_pk_bf16_f32 v30, v20, v21
    v_cvt_pk_bf16_f32 v31, v22, v23
    buffer_store_dwordx2 v[30:31], v7, s[24:27], 0 offen offset:512
    v_accvgpr_read_b32 v20, a72
    v_accvgpr_read_b32 v24, a88
    v_accvgpr_read_b32 v21, a73
    v_accvgpr_read_b32 v25, a89
    v_accvgpr_read_b32 v22, a74
    v_accvgpr_read_b32 v26, a90
    v_accvgpr_read_b32 v23, a75
    v_accvgpr_read_b32 v27, a91
    v_cvt_pk_bf16_f32 v9, v20, v21
    v_lshlrev_b32 v20, 16, v9
    v_and_b32 v21, 0xffff0000, v9
    v_cvt_pk_bf16_f32 v9, v22, v23
    v_lshlrev_b32 v22, 16, v9
    v_and_b32 v23, 0xffff0000, v9
    v_cvt_pk_bf16_f32 v9, v24, v25
    v_lshlrev_b32 v24, 16, v9
    v_and_b32 v25, 0xffff0000, v9
    v_cvt_pk_bf16_f32 v9, v26, v27
    v_lshlrev_b32 v26, 16, v9
    v_and_b32 v27, 0xffff0000, v9
    v_max_f32 v20, 0, v20
    v_mul_f32 v20, v20, v24
    v_max_f32 v21, 0, v21
    v_mul_f32 v21, v21, v25
    v_max_f32 v22, 0, v22
    v_mul_f32 v22, v22, v26
    v_max_f32 v23, 0, v23
    v_mul_f32 v23, v23, v27
    v_cvt_pk_bf16_f32 v32, v20, v21
    v_cvt_pk_bf16_f32 v33, v22, v23
    buffer_store_dwordx2 v[32:33], v7, s[24:27], 0 offen offset:1024
    v_accvgpr_read_b32 v20, a76
    v_accvgpr_read_b32 v24, a92
    v_accvgpr_read_b32 v21, a77
    v_accvgpr_read_b32 v25, a93
    v_accvgpr_read_b32 v22, a78
    v_accvgpr_read_b32 v26, a94
    v_accvgpr_read_b32 v23, a79
    v_accvgpr_read_b32 v27, a95
    v_cvt_pk_bf16_f32 v9, v20, v21
    v_lshlrev_b32 v20, 16, v9
    v_and_b32 v21, 0xffff0000, v9
    v_cvt_pk_bf16_f32 v9, v22, v23
    v_lshlrev_b32 v22, 16, v9
    v_and_b32 v23, 0xffff0000, v9
    v_cvt_pk_bf16_f32 v9, v24, v25
    v_lshlrev_b32 v24, 16, v9
    v_and_b32 v25, 0xffff0000, v9
    v_cvt_pk_bf16_f32 v9, v26, v27
    v_lshlrev_b32 v26, 16, v9
    v_and_b32 v27, 0xffff0000, v9
    v_max_f32 v20, 0, v20
    v_mul_f32 v20, v20, v24
    v_max_f32 v21, 0, v21
    v_mul_f32 v21, v21, v25
    v_max_f32 v22, 0, v22
    v_mul_f32 v22, v22, v26
    v_max_f32 v23, 0, v23
    v_mul_f32 v23, v23, v27
    v_cvt_pk_bf16_f32 v34, v20, v21
    v_cvt_pk_bf16_f32 v35, v22, v23
    buffer_store_dwordx2 v[34:35], v7, s[24:27], 0 offen offset:1536
    v_add_u32 v7, 57344, v7
    v_accvgpr_read_b32 v20, a96
    v_accvgpr_read_b32 v24, a112
    v_accvgpr_read_b32 v21, a97
    v_accvgpr_read_b32 v25, a113
    v_accvgpr_read_b32 v22, a98
    v_accvgpr_read_b32 v26, a114
    v_accvgpr_read_b32 v23, a99
    v_accvgpr_read_b32 v27, a115
    v_cvt_pk_bf16_f32 v9, v20, v21
    v_lshlrev_b32 v20, 16, v9
    v_and_b32 v21, 0xffff0000, v9
    v_cvt_pk_bf16_f32 v9, v22, v23
    v_lshlrev_b32 v22, 16, v9
    v_and_b32 v23, 0xffff0000, v9
    v_cvt_pk_bf16_f32 v9, v24, v25
    v_lshlrev_b32 v24, 16, v9
    v_and_b32 v25, 0xffff0000, v9
    v_cvt_pk_bf16_f32 v9, v26, v27
    v_lshlrev_b32 v26, 16, v9
    v_and_b32 v27, 0xffff0000, v9
    v_max_f32 v20, 0, v20
    v_mul_f32 v20, v20, v24
    v_max_f32 v21, 0, v21
    v_mul_f32 v21, v21, v25
    v_max_f32 v22, 0, v22
    v_mul_f32 v22, v22, v26
    v_max_f32 v23, 0, v23
    v_mul_f32 v23, v23, v27
    v_cvt_pk_bf16_f32 v36, v20, v21
    v_cvt_pk_bf16_f32 v37, v22, v23
    buffer_store_dwordx2 v[36:37], v7, s[24:27], 0 offen offset:0
    v_accvgpr_read_b32 v20, a100
    v_accvgpr_read_b32 v24, a116
    v_accvgpr_read_b32 v21, a101
    v_accvgpr_read_b32 v25, a117
    v_accvgpr_read_b32 v22, a102
    v_accvgpr_read_b32 v26, a118
    v_accvgpr_read_b32 v23, a103
    v_accvgpr_read_b32 v27, a119
    v_cvt_pk_bf16_f32 v9, v20, v21
    v_lshlrev_b32 v20, 16, v9
    v_and_b32 v21, 0xffff0000, v9
    v_cvt_pk_bf16_f32 v9, v22, v23
    v_lshlrev_b32 v22, 16, v9
    v_and_b32 v23, 0xffff0000, v9
    v_cvt_pk_bf16_f32 v9, v24, v25
    v_lshlrev_b32 v24, 16, v9
    v_and_b32 v25, 0xffff0000, v9
    v_cvt_pk_bf16_f32 v9, v26, v27
    v_lshlrev_b32 v26, 16, v9
    v_and_b32 v27, 0xffff0000, v9
    v_max_f32 v20, 0, v20
    v_mul_f32 v20, v20, v24
    v_max_f32 v21, 0, v21
    v_mul_f32 v21, v21, v25
    v_max_f32 v22, 0, v22
    v_mul_f32 v22, v22, v26
    v_max_f32 v23, 0, v23
    v_mul_f32 v23, v23, v27
    v_cvt_pk_bf16_f32 v38, v20, v21
    v_cvt_pk_bf16_f32 v39, v22, v23
    buffer_store_dwordx2 v[38:39], v7, s[24:27], 0 offen offset:512
    v_accvgpr_read_b32 v20, a104
    v_accvgpr_read_b32 v24, a120
    v_accvgpr_read_b32 v21, a105
    v_accvgpr_read_b32 v25, a121
    v_accvgpr_read_b32 v22, a106
    v_accvgpr_read_b32 v26, a122
    v_accvgpr_read_b32 v23, a107
    v_accvgpr_read_b32 v27, a123
    v_cvt_pk_bf16_f32 v9, v20, v21
    v_lshlrev_b32 v20, 16, v9
    v_and_b32 v21, 0xffff0000, v9
    v_cvt_pk_bf16_f32 v9, v22, v23
    v_lshlrev_b32 v22, 16, v9
    v_and_b32 v23, 0xffff0000, v9
    v_cvt_pk_bf16_f32 v9, v24, v25
    v_lshlrev_b32 v24, 16, v9
    v_and_b32 v25, 0xffff0000, v9
    v_cvt_pk_bf16_f32 v9, v26, v27
    v_lshlrev_b32 v26, 16, v9
    v_and_b32 v27, 0xffff0000, v9
    v_max_f32 v20, 0, v20
    v_mul_f32 v20, v20, v24
    v_max_f32 v21, 0, v21
    v_mul_f32 v21, v21, v25
    v_max_f32 v22, 0, v22
    v_mul_f32 v22, v22, v26
    v_max_f32 v23, 0, v23
    v_mul_f32 v23, v23, v27
    v_cvt_pk_bf16_f32 v40, v20, v21
    v_cvt_pk_bf16_f32 v41, v22, v23
    buffer_store_dwordx2 v[40:41], v7, s[24:27], 0 offen offset:1024
    v_accvgpr_read_b32 v20, a108
    v_accvgpr_read_b32 v24, a124
    v_accvgpr_read_b32 v21, a109
    v_accvgpr_read_b32 v25, a125
    v_accvgpr_read_b32 v22, a110
    v_accvgpr_read_b32 v26, a126
    v_accvgpr_read_b32 v23, a111
    v_accvgpr_read_b32 v27, a127
    v_cvt_pk_bf16_f32 v9, v20, v21
    v_lshlrev_b32 v20, 16, v9
    v_and_b32 v21, 0xffff0000, v9
    v_cvt_pk_bf16_f32 v9, v22, v23
    v_lshlrev_b32 v22, 16, v9
    v_and_b32 v23, 0xffff0000, v9
    v_cvt_pk_bf16_f32 v9, v24, v25
    v_lshlrev_b32 v24, 16, v9
    v_and_b32 v25, 0xffff0000, v9
    v_cvt_pk_bf16_f32 v9, v26, v27
    v_lshlrev_b32 v26, 16, v9
    v_and_b32 v27, 0xffff0000, v9
    v_max_f32 v20, 0, v20
    v_mul_f32 v20, v20, v24
    v_max_f32 v21, 0, v21
    v_mul_f32 v21, v21, v25
    v_max_f32 v22, 0, v22
    v_mul_f32 v22, v22, v26
    v_max_f32 v23, 0, v23
    v_mul_f32 v23, v23, v27
    v_cvt_pk_bf16_f32 v42, v20, v21
    v_cvt_pk_bf16_f32 v43, v22, v23
    buffer_store_dwordx2 v[42:43], v7, s[24:27], 0 offen offset:1536
g1_end:
    s_endpgm
.globl g2_kernel
.p2align 8
.type g2_kernel,@function
g2_kernel:
    s_cmp_ge_u32 s2, 256
    s_cbranch_scc1 g2_end
    s_load_dwordx2 s[8:9], s[0:1], 80
    s_load_dwordx2 s[10:11], s[0:1], 96
    s_waitcnt lgkmcnt(0)
    s_add_u32 s12, s10, 16777216
    s_addc_u32 s13, s11, 0
    s_mov_b32 s14, 8388608
    s_mov_b32 s15, 0x20000
    s_add_u32 s16, s10, 12582912
    s_addc_u32 s17, s11, 0
    s_mov_b32 s18, 2097152
    s_mov_b32 s19, 0x20000
    s_add_u32 s20, s10, 4194304
    s_addc_u32 s21, s11, 0
    s_mov_b32 s22, 2097152
    s_mov_b32 s23, 0x20000
    s_add_u32 s24, s8, 0
    s_addc_u32 s25, s9, 0
    s_mov_b32 s26, 2097152
    s_mov_b32 s27, 0x20000
    s_and_b32 s28, s2, 31
    s_lshr_b32 s29, s2, 5
    v_lshrrev_b32 v1, 6, v0
    v_and_b32 v2, 63, v0
    v_and_b32 v3, 15, v2
    v_lshrrev_b32 v4, 4, v2
    v_lshrrev_b32 v5, 1, v1
    v_and_b32 v6, 1, v1
    v_mul_u32_u24 v7, 114688, v5
    v_lshl_add_u32 v7, v2, 4, v7
    s_mul_i32 s30, s28, 229376
    v_add_u32 v7, s30, v7
    v_add_u32 v9, 57344, v7
    v_mul_u32_u24 v8, 114688, v6
    v_lshl_add_u32 v8, v2, 4, v8
    s_mul_i32 s30, s29, 229376
    v_add_u32 v8, s30, v8
    v_add_u32 v10, 57344, v8
    v_mov_b32 v16, 0
    v_mov_b32 v17, 0
    v_mov_b32 v18, 0
    v_mov_b32 v19, 0
    v_mov_b32 v20, 0
    v_mov_b32 v21, 0
    v_mov_b32 v22, 0
    v_mov_b32 v23, 0
    v_mov_b32 v24, 0
    v_mov_b32 v25, 0
    v_mov_b32 v26, 0
    v_mov_b32 v27, 0
    v_mov_b32 v28, 0
    v_mov_b32 v29, 0
    v_mov_b32 v30, 0
    v_mov_b32 v31, 0
    s_mov_b32 s31, 0
    buffer_load_dwordx4 v[32:35], v7, s[12:15], s31 offen
    buffer_load_dwordx4 v[36:39], v9, s[12:15], s31 offen
    buffer_load_dwordx4 v[40:43], v8, s[16:19], s31 offen
    buffer_load_dwordx4 v[44:47], v10, s[16:19], s31 offen
    s_mov_b32 s31, 1024
    buffer_load_dwordx4 v[48:51], v7, s[12:15], s31 offen
    buffer_load_dwordx4 v[52:55], v9, s[12:15], s31 offen
    buffer_load_dwordx4 v[56:59], v8, s[16:19], s31 offen
    buffer_load_dwordx4 v[60:63], v10, s[16:19], s31 offen
    s_mov_b32 s31, 2048
    buffer_load_dwordx4 v[64:67], v7, s[12:15], s31 offen
    buffer_load_dwordx4 v[68:71], v9, s[12:15], s31 offen
    buffer_load_dwordx4 v[72:75], v8, s[16:19], s31 offen
    buffer_load_dwordx4 v[76:79], v10, s[16:19], s31 offen
    s_mov_b32 s31, 3072
    buffer_load_dwordx4 v[80:83], v7, s[12:15], s31 offen
    buffer_load_dwordx4 v[84:87], v9, s[12:15], s31 offen
    buffer_load_dwordx4 v[88:91], v8, s[16:19], s31 offen
    buffer_load_dwordx4 v[92:95], v10, s[16:19], s31 offen
    s_mov_b32 s31, 4096
    buffer_load_dwordx4 v[96:99], v7, s[12:15], s31 offen
    buffer_load_dwordx4 v[100:103], v9, s[12:15], s31 offen
    buffer_load_dwordx4 v[104:107], v8, s[16:19], s31 offen
    buffer_load_dwordx4 v[108:111], v10, s[16:19], s31 offen
    s_mov_b32 s31, 5120
    buffer_load_dwordx4 v[112:115], v7, s[12:15], s31 offen
    buffer_load_dwordx4 v[116:119], v9, s[12:15], s31 offen
    buffer_load_dwordx4 v[120:123], v8, s[16:19], s31 offen
    buffer_load_dwordx4 v[124:127], v10, s[16:19], s31 offen
    s_mov_b32 s31, 6144
    buffer_load_dwordx4 v[128:131], v7, s[12:15], s31 offen
    buffer_load_dwordx4 v[132:135], v9, s[12:15], s31 offen
    buffer_load_dwordx4 v[136:139], v8, s[16:19], s31 offen
    buffer_load_dwordx4 v[140:143], v10, s[16:19], s31 offen
    s_mov_b32 s31, 7168
    buffer_load_dwordx4 v[144:147], v7, s[12:15], s31 offen
    buffer_load_dwordx4 v[148:151], v9, s[12:15], s31 offen
    buffer_load_dwordx4 v[152:155], v8, s[16:19], s31 offen
    buffer_load_dwordx4 v[156:159], v10, s[16:19], s31 offen
    s_waitcnt vmcnt(28)
    v_mfma_f32_16x16x32_bf16 v[16:19], v[40:43], v[32:35], v[16:19]
    v_mfma_f32_16x16x32_bf16 v[20:23], v[44:47], v[32:35], v[20:23]
    v_mfma_f32_16x16x32_bf16 v[24:27], v[40:43], v[36:39], v[24:27]
    v_mfma_f32_16x16x32_bf16 v[28:31], v[44:47], v[36:39], v[28:31]
    s_mov_b32 s31, 8192
    buffer_load_dwordx4 v[32:35], v7, s[12:15], s31 offen
    buffer_load_dwordx4 v[36:39], v9, s[12:15], s31 offen
    buffer_load_dwordx4 v[40:43], v8, s[16:19], s31 offen
    buffer_load_dwordx4 v[44:47], v10, s[16:19], s31 offen
    s_waitcnt vmcnt(28)
    v_mfma_f32_16x16x32_bf16 v[16:19], v[56:59], v[48:51], v[16:19]
    v_mfma_f32_16x16x32_bf16 v[20:23], v[60:63], v[48:51], v[20:23]
    v_mfma_f32_16x16x32_bf16 v[24:27], v[56:59], v[52:55], v[24:27]
    v_mfma_f32_16x16x32_bf16 v[28:31], v[60:63], v[52:55], v[28:31]
    s_mov_b32 s31, 9216
    buffer_load_dwordx4 v[48:51], v7, s[12:15], s31 offen
    buffer_load_dwordx4 v[52:55], v9, s[12:15], s31 offen
    buffer_load_dwordx4 v[56:59], v8, s[16:19], s31 offen
    buffer_load_dwordx4 v[60:63], v10, s[16:19], s31 offen
    s_waitcnt vmcnt(28)
    v_mfma_f32_16x16x32_bf16 v[16:19], v[72:75], v[64:67], v[16:19]
    v_mfma_f32_16x16x32_bf16 v[20:23], v[76:79], v[64:67], v[20:23]
    v_mfma_f32_16x16x32_bf16 v[24:27], v[72:75], v[68:71], v[24:27]
    v_mfma_f32_16x16x32_bf16 v[28:31], v[76:79], v[68:71], v[28:31]
    s_mov_b32 s31, 10240
    buffer_load_dwordx4 v[64:67], v7, s[12:15], s31 offen
    buffer_load_dwordx4 v[68:71], v9, s[12:15], s31 offen
    buffer_load_dwordx4 v[72:75], v8, s[16:19], s31 offen
    buffer_load_dwordx4 v[76:79], v10, s[16:19], s31 offen
    s_waitcnt vmcnt(28)
    v_mfma_f32_16x16x32_bf16 v[16:19], v[88:91], v[80:83], v[16:19]
    v_mfma_f32_16x16x32_bf16 v[20:23], v[92:95], v[80:83], v[20:23]
    v_mfma_f32_16x16x32_bf16 v[24:27], v[88:91], v[84:87], v[24:27]
    v_mfma_f32_16x16x32_bf16 v[28:31], v[92:95], v[84:87], v[28:31]
    s_mov_b32 s31, 11264
    buffer_load_dwordx4 v[80:83], v7, s[12:15], s31 offen
    buffer_load_dwordx4 v[84:87], v9, s[12:15], s31 offen
    buffer_load_dwordx4 v[88:91], v8, s[16:19], s31 offen
    buffer_load_dwordx4 v[92:95], v10, s[16:19], s31 offen
    s_waitcnt vmcnt(28)
    v_mfma_f32_16x16x32_bf16 v[16:19], v[104:107], v[96:99], v[16:19]
    v_mfma_f32_16x16x32_bf16 v[20:23], v[108:111], v[96:99], v[20:23]
    v_mfma_f32_16x16x32_bf16 v[24:27], v[104:107], v[100:103], v[24:27]
    v_mfma_f32_16x16x32_bf16 v[28:31], v[108:111], v[100:103], v[28:31]
    s_mov_b32 s31, 12288
    buffer_load_dwordx4 v[96:99], v7, s[12:15], s31 offen
    buffer_load_dwordx4 v[100:103], v9, s[12:15], s31 offen
    buffer_load_dwordx4 v[104:107], v8, s[16:19], s31 offen
    buffer_load_dwordx4 v[108:111], v10, s[16:19], s31 offen
    s_waitcnt vmcnt(28)
    v_mfma_f32_16x16x32_bf16 v[16:19], v[120:123], v[112:115], v[16:19]
    v_mfma_f32_16x16x32_bf16 v[20:23], v[124:127], v[112:115], v[20:23]
    v_mfma_f32_16x16x32_bf16 v[24:27], v[120:123], v[116:119], v[24:27]
    v_mfma_f32_16x16x32_bf16 v[28:31], v[124:127], v[116:119], v[28:31]
    s_mov_b32 s31, 13312
    buffer_load_dwordx4 v[112:115], v7, s[12:15], s31 offen
    buffer_load_dwordx4 v[116:119], v9, s[12:15], s31 offen
    buffer_load_dwordx4 v[120:123], v8, s[16:19], s31 offen
    buffer_load_dwordx4 v[124:127], v10, s[16:19], s31 offen
    s_waitcnt vmcnt(28)
    v_mfma_f32_16x16x32_bf16 v[16:19], v[136:139], v[128:131], v[16:19]
    v_mfma_f32_16x16x32_bf16 v[20:23], v[140:143], v[128:131], v[20:23]
    v_mfma_f32_16x16x32_bf16 v[24:27], v[136:139], v[132:135], v[24:27]
    v_mfma_f32_16x16x32_bf16 v[28:31], v[140:143], v[132:135], v[28:31]
    s_mov_b32 s31, 14336
    buffer_load_dwordx4 v[128:131], v7, s[12:15], s31 offen
    buffer_load_dwordx4 v[132:135], v9, s[12:15], s31 offen
    buffer_load_dwordx4 v[136:139], v8, s[16:19], s31 offen
    buffer_load_dwordx4 v[140:143], v10, s[16:19], s31 offen
    s_waitcnt vmcnt(28)
    v_mfma_f32_16x16x32_bf16 v[16:19], v[152:155], v[144:147], v[16:19]
    v_mfma_f32_16x16x32_bf16 v[20:23], v[156:159], v[144:147], v[20:23]
    v_mfma_f32_16x16x32_bf16 v[24:27], v[152:155], v[148:151], v[24:27]
    v_mfma_f32_16x16x32_bf16 v[28:31], v[156:159], v[148:151], v[28:31]
    s_mov_b32 s31, 15360
    buffer_load_dwordx4 v[144:147], v7, s[12:15], s31 offen
    buffer_load_dwordx4 v[148:151], v9, s[12:15], s31 offen
    buffer_load_dwordx4 v[152:155], v8, s[16:19], s31 offen
    buffer_load_dwordx4 v[156:159], v10, s[16:19], s31 offen
    s_waitcnt vmcnt(28)
    v_mfma_f32_16x16x32_bf16 v[16:19], v[40:43], v[32:35], v[16:19]
    v_mfma_f32_16x16x32_bf16 v[20:23], v[44:47], v[32:35], v[20:23]
    v_mfma_f32_16x16x32_bf16 v[24:27], v[40:43], v[36:39], v[24:27]
    v_mfma_f32_16x16x32_bf16 v[28:31], v[44:47], v[36:39], v[28:31]
    s_mov_b32 s31, 16384
    buffer_load_dwordx4 v[32:35], v7, s[12:15], s31 offen
    buffer_load_dwordx4 v[36:39], v9, s[12:15], s31 offen
    buffer_load_dwordx4 v[40:43], v8, s[16:19], s31 offen
    buffer_load_dwordx4 v[44:47], v10, s[16:19], s31 offen
    s_waitcnt vmcnt(28)
    v_mfma_f32_16x16x32_bf16 v[16:19], v[56:59], v[48:51], v[16:19]
    v_mfma_f32_16x16x32_bf16 v[20:23], v[60:63], v[48:51], v[20:23]
    v_mfma_f32_16x16x32_bf16 v[24:27], v[56:59], v[52:55], v[24:27]
    v_mfma_f32_16x16x32_bf16 v[28:31], v[60:63], v[52:55], v[28:31]
    s_mov_b32 s31, 17408
    buffer_load_dwordx4 v[48:51], v7, s[12:15], s31 offen
    buffer_load_dwordx4 v[52:55], v9, s[12:15], s31 offen
    buffer_load_dwordx4 v[56:59], v8, s[16:19], s31 offen
    buffer_load_dwordx4 v[60:63], v10, s[16:19], s31 offen
    s_waitcnt vmcnt(28)
    v_mfma_f32_16x16x32_bf16 v[16:19], v[72:75], v[64:67], v[16:19]
    v_mfma_f32_16x16x32_bf16 v[20:23], v[76:79], v[64:67], v[20:23]
    v_mfma_f32_16x16x32_bf16 v[24:27], v[72:75], v[68:71], v[24:27]
    v_mfma_f32_16x16x32_bf16 v[28:31], v[76:79], v[68:71], v[28:31]
    s_mov_b32 s31, 18432
    buffer_load_dwordx4 v[64:67], v7, s[12:15], s31 offen
    buffer_load_dwordx4 v[68:71], v9, s[12:15], s31 offen
    buffer_load_dwordx4 v[72:75], v8, s[16:19], s31 offen
    buffer_load_dwordx4 v[76:79], v10, s[16:19], s31 offen
    s_waitcnt vmcnt(28)
    v_mfma_f32_16x16x32_bf16 v[16:19], v[88:91], v[80:83], v[16:19]
    v_mfma_f32_16x16x32_bf16 v[20:23], v[92:95], v[80:83], v[20:23]
    v_mfma_f32_16x16x32_bf16 v[24:27], v[88:91], v[84:87], v[24:27]
    v_mfma_f32_16x16x32_bf16 v[28:31], v[92:95], v[84:87], v[28:31]
    s_mov_b32 s31, 19456
    buffer_load_dwordx4 v[80:83], v7, s[12:15], s31 offen
    buffer_load_dwordx4 v[84:87], v9, s[12:15], s31 offen
    buffer_load_dwordx4 v[88:91], v8, s[16:19], s31 offen
    buffer_load_dwordx4 v[92:95], v10, s[16:19], s31 offen
    s_waitcnt vmcnt(28)
    v_mfma_f32_16x16x32_bf16 v[16:19], v[104:107], v[96:99], v[16:19]
    v_mfma_f32_16x16x32_bf16 v[20:23], v[108:111], v[96:99], v[20:23]
    v_mfma_f32_16x16x32_bf16 v[24:27], v[104:107], v[100:103], v[24:27]
    v_mfma_f32_16x16x32_bf16 v[28:31], v[108:111], v[100:103], v[28:31]
    s_mov_b32 s31, 20480
    buffer_load_dwordx4 v[96:99], v7, s[12:15], s31 offen
    buffer_load_dwordx4 v[100:103], v9, s[12:15], s31 offen
    buffer_load_dwordx4 v[104:107], v8, s[16:19], s31 offen
    buffer_load_dwordx4 v[108:111], v10, s[16:19], s31 offen
    s_waitcnt vmcnt(28)
    v_mfma_f32_16x16x32_bf16 v[16:19], v[120:123], v[112:115], v[16:19]
    v_mfma_f32_16x16x32_bf16 v[20:23], v[124:127], v[112:115], v[20:23]
    v_mfma_f32_16x16x32_bf16 v[24:27], v[120:123], v[116:119], v[24:27]
    v_mfma_f32_16x16x32_bf16 v[28:31], v[124:127], v[116:119], v[28:31]
    s_mov_b32 s31, 21504
    buffer_load_dwordx4 v[112:115], v7, s[12:15], s31 offen
    buffer_load_dwordx4 v[116:119], v9, s[12:15], s31 offen
    buffer_load_dwordx4 v[120:123], v8, s[16:19], s31 offen
    buffer_load_dwordx4 v[124:127], v10, s[16:19], s31 offen
    s_waitcnt vmcnt(28)
    v_mfma_f32_16x16x32_bf16 v[16:19], v[136:139], v[128:131], v[16:19]
    v_mfma_f32_16x16x32_bf16 v[20:23], v[140:143], v[128:131], v[20:23]
    v_mfma_f32_16x16x32_bf16 v[24:27], v[136:139], v[132:135], v[24:27]
    v_mfma_f32_16x16x32_bf16 v[28:31], v[140:143], v[132:135], v[28:31]
    s_mov_b32 s31, 22528
    buffer_load_dwordx4 v[128:131], v7, s[12:15], s31 offen
    buffer_load_dwordx4 v[132:135], v9, s[12:15], s31 offen
    buffer_load_dwordx4 v[136:139], v8, s[16:19], s31 offen
    buffer_load_dwordx4 v[140:143], v10, s[16:19], s31 offen
    s_waitcnt vmcnt(28)
    v_mfma_f32_16x16x32_bf16 v[16:19], v[152:155], v[144:147], v[16:19]
    v_mfma_f32_16x16x32_bf16 v[20:23], v[156:159], v[144:147], v[20:23]
    v_mfma_f32_16x16x32_bf16 v[24:27], v[152:155], v[148:151], v[24:27]
    v_mfma_f32_16x16x32_bf16 v[28:31], v[156:159], v[148:151], v[28:31]
    s_mov_b32 s31, 23552
    buffer_load_dwordx4 v[144:147], v7, s[12:15], s31 offen
    buffer_load_dwordx4 v[148:151], v9, s[12:15], s31 offen
    buffer_load_dwordx4 v[152:155], v8, s[16:19], s31 offen
    buffer_load_dwordx4 v[156:159], v10, s[16:19], s31 offen
    s_waitcnt vmcnt(28)
    v_mfma_f32_16x16x32_bf16 v[16:19], v[40:43], v[32:35], v[16:19]
    v_mfma_f32_16x16x32_bf16 v[20:23], v[44:47], v[32:35], v[20:23]
    v_mfma_f32_16x16x32_bf16 v[24:27], v[40:43], v[36:39], v[24:27]
    v_mfma_f32_16x16x32_bf16 v[28:31], v[44:47], v[36:39], v[28:31]
    s_mov_b32 s31, 24576
    buffer_load_dwordx4 v[32:35], v7, s[12:15], s31 offen
    buffer_load_dwordx4 v[36:39], v9, s[12:15], s31 offen
    buffer_load_dwordx4 v[40:43], v8, s[16:19], s31 offen
    buffer_load_dwordx4 v[44:47], v10, s[16:19], s31 offen
    s_waitcnt vmcnt(28)
    v_mfma_f32_16x16x32_bf16 v[16:19], v[56:59], v[48:51], v[16:19]
    v_mfma_f32_16x16x32_bf16 v[20:23], v[60:63], v[48:51], v[20:23]
    v_mfma_f32_16x16x32_bf16 v[24:27], v[56:59], v[52:55], v[24:27]
    v_mfma_f32_16x16x32_bf16 v[28:31], v[60:63], v[52:55], v[28:31]
    s_mov_b32 s31, 25600
    buffer_load_dwordx4 v[48:51], v7, s[12:15], s31 offen
    buffer_load_dwordx4 v[52:55], v9, s[12:15], s31 offen
    buffer_load_dwordx4 v[56:59], v8, s[16:19], s31 offen
    buffer_load_dwordx4 v[60:63], v10, s[16:19], s31 offen
    s_waitcnt vmcnt(28)
    v_mfma_f32_16x16x32_bf16 v[16:19], v[72:75], v[64:67], v[16:19]
    v_mfma_f32_16x16x32_bf16 v[20:23], v[76:79], v[64:67], v[20:23]
    v_mfma_f32_16x16x32_bf16 v[24:27], v[72:75], v[68:71], v[24:27]
    v_mfma_f32_16x16x32_bf16 v[28:31], v[76:79], v[68:71], v[28:31]
    s_mov_b32 s31, 26624
    buffer_load_dwordx4 v[64:67], v7, s[12:15], s31 offen
    buffer_load_dwordx4 v[68:71], v9, s[12:15], s31 offen
    buffer_load_dwordx4 v[72:75], v8, s[16:19], s31 offen
    buffer_load_dwordx4 v[76:79], v10, s[16:19], s31 offen
    s_waitcnt vmcnt(28)
    v_mfma_f32_16x16x32_bf16 v[16:19], v[88:91], v[80:83], v[16:19]
    v_mfma_f32_16x16x32_bf16 v[20:23], v[92:95], v[80:83], v[20:23]
    v_mfma_f32_16x16x32_bf16 v[24:27], v[88:91], v[84:87], v[24:27]
    v_mfma_f32_16x16x32_bf16 v[28:31], v[92:95], v[84:87], v[28:31]
    s_mov_b32 s31, 27648
    buffer_load_dwordx4 v[80:83], v7, s[12:15], s31 offen
    buffer_load_dwordx4 v[84:87], v9, s[12:15], s31 offen
    buffer_load_dwordx4 v[88:91], v8, s[16:19], s31 offen
    buffer_load_dwordx4 v[92:95], v10, s[16:19], s31 offen
    s_waitcnt vmcnt(28)
    v_mfma_f32_16x16x32_bf16 v[16:19], v[104:107], v[96:99], v[16:19]
    v_mfma_f32_16x16x32_bf16 v[20:23], v[108:111], v[96:99], v[20:23]
    v_mfma_f32_16x16x32_bf16 v[24:27], v[104:107], v[100:103], v[24:27]
    v_mfma_f32_16x16x32_bf16 v[28:31], v[108:111], v[100:103], v[28:31]
    s_mov_b32 s31, 28672
    buffer_load_dwordx4 v[96:99], v7, s[12:15], s31 offen
    buffer_load_dwordx4 v[100:103], v9, s[12:15], s31 offen
    buffer_load_dwordx4 v[104:107], v8, s[16:19], s31 offen
    buffer_load_dwordx4 v[108:111], v10, s[16:19], s31 offen
    s_waitcnt vmcnt(28)
    v_mfma_f32_16x16x32_bf16 v[16:19], v[120:123], v[112:115], v[16:19]
    v_mfma_f32_16x16x32_bf16 v[20:23], v[124:127], v[112:115], v[20:23]
    v_mfma_f32_16x16x32_bf16 v[24:27], v[120:123], v[116:119], v[24:27]
    v_mfma_f32_16x16x32_bf16 v[28:31], v[124:127], v[116:119], v[28:31]
    s_mov_b32 s31, 29696
    buffer_load_dwordx4 v[112:115], v7, s[12:15], s31 offen
    buffer_load_dwordx4 v[116:119], v9, s[12:15], s31 offen
    buffer_load_dwordx4 v[120:123], v8, s[16:19], s31 offen
    buffer_load_dwordx4 v[124:127], v10, s[16:19], s31 offen
    s_waitcnt vmcnt(28)
    v_mfma_f32_16x16x32_bf16 v[16:19], v[136:139], v[128:131], v[16:19]
    v_mfma_f32_16x16x32_bf16 v[20:23], v[140:143], v[128:131], v[20:23]
    v_mfma_f32_16x16x32_bf16 v[24:27], v[136:139], v[132:135], v[24:27]
    v_mfma_f32_16x16x32_bf16 v[28:31], v[140:143], v[132:135], v[28:31]
    s_mov_b32 s31, 30720
    buffer_load_dwordx4 v[128:131], v7, s[12:15], s31 offen
    buffer_load_dwordx4 v[132:135], v9, s[12:15], s31 offen
    buffer_load_dwordx4 v[136:139], v8, s[16:19], s31 offen
    buffer_load_dwordx4 v[140:143], v10, s[16:19], s31 offen
    s_waitcnt vmcnt(28)
    v_mfma_f32_16x16x32_bf16 v[16:19], v[152:155], v[144:147], v[16:19]
    v_mfma_f32_16x16x32_bf16 v[20:23], v[156:159], v[144:147], v[20:23]
    v_mfma_f32_16x16x32_bf16 v[24:27], v[152:155], v[148:151], v[24:27]
    v_mfma_f32_16x16x32_bf16 v[28:31], v[156:159], v[148:151], v[28:31]
    s_mov_b32 s31, 31744
    buffer_load_dwordx4 v[144:147], v7, s[12:15], s31 offen
    buffer_load_dwordx4 v[148:151], v9, s[12:15], s31 offen
    buffer_load_dwordx4 v[152:155], v8, s[16:19], s31 offen
    buffer_load_dwordx4 v[156:159], v10, s[16:19], s31 offen
    s_waitcnt vmcnt(28)
    v_mfma_f32_16x16x32_bf16 v[16:19], v[40:43], v[32:35], v[16:19]
    v_mfma_f32_16x16x32_bf16 v[20:23], v[44:47], v[32:35], v[20:23]
    v_mfma_f32_16x16x32_bf16 v[24:27], v[40:43], v[36:39], v[24:27]
    v_mfma_f32_16x16x32_bf16 v[28:31], v[44:47], v[36:39], v[28:31]
    s_mov_b32 s31, 32768
    buffer_load_dwordx4 v[32:35], v7, s[12:15], s31 offen
    buffer_load_dwordx4 v[36:39], v9, s[12:15], s31 offen
    buffer_load_dwordx4 v[40:43], v8, s[16:19], s31 offen
    buffer_load_dwordx4 v[44:47], v10, s[16:19], s31 offen
    s_waitcnt vmcnt(28)
    v_mfma_f32_16x16x32_bf16 v[16:19], v[56:59], v[48:51], v[16:19]
    v_mfma_f32_16x16x32_bf16 v[20:23], v[60:63], v[48:51], v[20:23]
    v_mfma_f32_16x16x32_bf16 v[24:27], v[56:59], v[52:55], v[24:27]
    v_mfma_f32_16x16x32_bf16 v[28:31], v[60:63], v[52:55], v[28:31]
    s_mov_b32 s31, 33792
    buffer_load_dwordx4 v[48:51], v7, s[12:15], s31 offen
    buffer_load_dwordx4 v[52:55], v9, s[12:15], s31 offen
    buffer_load_dwordx4 v[56:59], v8, s[16:19], s31 offen
    buffer_load_dwordx4 v[60:63], v10, s[16:19], s31 offen
    s_waitcnt vmcnt(28)
    v_mfma_f32_16x16x32_bf16 v[16:19], v[72:75], v[64:67], v[16:19]
    v_mfma_f32_16x16x32_bf16 v[20:23], v[76:79], v[64:67], v[20:23]
    v_mfma_f32_16x16x32_bf16 v[24:27], v[72:75], v[68:71], v[24:27]
    v_mfma_f32_16x16x32_bf16 v[28:31], v[76:79], v[68:71], v[28:31]
    s_mov_b32 s31, 34816
    buffer_load_dwordx4 v[64:67], v7, s[12:15], s31 offen
    buffer_load_dwordx4 v[68:71], v9, s[12:15], s31 offen
    buffer_load_dwordx4 v[72:75], v8, s[16:19], s31 offen
    buffer_load_dwordx4 v[76:79], v10, s[16:19], s31 offen
    s_waitcnt vmcnt(28)
    v_mfma_f32_16x16x32_bf16 v[16:19], v[88:91], v[80:83], v[16:19]
    v_mfma_f32_16x16x32_bf16 v[20:23], v[92:95], v[80:83], v[20:23]
    v_mfma_f32_16x16x32_bf16 v[24:27], v[88:91], v[84:87], v[24:27]
    v_mfma_f32_16x16x32_bf16 v[28:31], v[92:95], v[84:87], v[28:31]
    s_mov_b32 s31, 35840
    buffer_load_dwordx4 v[80:83], v7, s[12:15], s31 offen
    buffer_load_dwordx4 v[84:87], v9, s[12:15], s31 offen
    buffer_load_dwordx4 v[88:91], v8, s[16:19], s31 offen
    buffer_load_dwordx4 v[92:95], v10, s[16:19], s31 offen
    s_waitcnt vmcnt(28)
    v_mfma_f32_16x16x32_bf16 v[16:19], v[104:107], v[96:99], v[16:19]
    v_mfma_f32_16x16x32_bf16 v[20:23], v[108:111], v[96:99], v[20:23]
    v_mfma_f32_16x16x32_bf16 v[24:27], v[104:107], v[100:103], v[24:27]
    v_mfma_f32_16x16x32_bf16 v[28:31], v[108:111], v[100:103], v[28:31]
    s_mov_b32 s31, 36864
    buffer_load_dwordx4 v[96:99], v7, s[12:15], s31 offen
    buffer_load_dwordx4 v[100:103], v9, s[12:15], s31 offen
    buffer_load_dwordx4 v[104:107], v8, s[16:19], s31 offen
    buffer_load_dwordx4 v[108:111], v10, s[16:19], s31 offen
    s_waitcnt vmcnt(28)
    v_mfma_f32_16x16x32_bf16 v[16:19], v[120:123], v[112:115], v[16:19]
    v_mfma_f32_16x16x32_bf16 v[20:23], v[124:127], v[112:115], v[20:23]
    v_mfma_f32_16x16x32_bf16 v[24:27], v[120:123], v[116:119], v[24:27]
    v_mfma_f32_16x16x32_bf16 v[28:31], v[124:127], v[116:119], v[28:31]
    s_mov_b32 s31, 37888
    buffer_load_dwordx4 v[112:115], v7, s[12:15], s31 offen
    buffer_load_dwordx4 v[116:119], v9, s[12:15], s31 offen
    buffer_load_dwordx4 v[120:123], v8, s[16:19], s31 offen
    buffer_load_dwordx4 v[124:127], v10, s[16:19], s31 offen
    s_waitcnt vmcnt(28)
    v_mfma_f32_16x16x32_bf16 v[16:19], v[136:139], v[128:131], v[16:19]
    v_mfma_f32_16x16x32_bf16 v[20:23], v[140:143], v[128:131], v[20:23]
    v_mfma_f32_16x16x32_bf16 v[24:27], v[136:139], v[132:135], v[24:27]
    v_mfma_f32_16x16x32_bf16 v[28:31], v[140:143], v[132:135], v[28:31]
    s_mov_b32 s31, 38912
    buffer_load_dwordx4 v[128:131], v7, s[12:15], s31 offen
    buffer_load_dwordx4 v[132:135], v9, s[12:15], s31 offen
    buffer_load_dwordx4 v[136:139], v8, s[16:19], s31 offen
    buffer_load_dwordx4 v[140:143], v10, s[16:19], s31 offen
    s_waitcnt vmcnt(28)
    v_mfma_f32_16x16x32_bf16 v[16:19], v[152:155], v[144:147], v[16:19]
    v_mfma_f32_16x16x32_bf16 v[20:23], v[156:159], v[144:147], v[20:23]
    v_mfma_f32_16x16x32_bf16 v[24:27], v[152:155], v[148:151], v[24:27]
    v_mfma_f32_16x16x32_bf16 v[28:31], v[156:159], v[148:151], v[28:31]
    s_mov_b32 s31, 39936
    buffer_load_dwordx4 v[144:147], v7, s[12:15], s31 offen
    buffer_load_dwordx4 v[148:151], v9, s[12:15], s31 offen
    buffer_load_dwordx4 v[152:155], v8, s[16:19], s31 offen
    buffer_load_dwordx4 v[156:159], v10, s[16:19], s31 offen
    s_waitcnt vmcnt(28)
    v_mfma_f32_16x16x32_bf16 v[16:19], v[40:43], v[32:35], v[16:19]
    v_mfma_f32_16x16x32_bf16 v[20:23], v[44:47], v[32:35], v[20:23]
    v_mfma_f32_16x16x32_bf16 v[24:27], v[40:43], v[36:39], v[24:27]
    v_mfma_f32_16x16x32_bf16 v[28:31], v[44:47], v[36:39], v[28:31]
    s_mov_b32 s31, 40960
    buffer_load_dwordx4 v[32:35], v7, s[12:15], s31 offen
    buffer_load_dwordx4 v[36:39], v9, s[12:15], s31 offen
    buffer_load_dwordx4 v[40:43], v8, s[16:19], s31 offen
    buffer_load_dwordx4 v[44:47], v10, s[16:19], s31 offen
    s_waitcnt vmcnt(28)
    v_mfma_f32_16x16x32_bf16 v[16:19], v[56:59], v[48:51], v[16:19]
    v_mfma_f32_16x16x32_bf16 v[20:23], v[60:63], v[48:51], v[20:23]
    v_mfma_f32_16x16x32_bf16 v[24:27], v[56:59], v[52:55], v[24:27]
    v_mfma_f32_16x16x32_bf16 v[28:31], v[60:63], v[52:55], v[28:31]
    s_mov_b32 s31, 41984
    buffer_load_dwordx4 v[48:51], v7, s[12:15], s31 offen
    buffer_load_dwordx4 v[52:55], v9, s[12:15], s31 offen
    buffer_load_dwordx4 v[56:59], v8, s[16:19], s31 offen
    buffer_load_dwordx4 v[60:63], v10, s[16:19], s31 offen
    s_waitcnt vmcnt(28)
    v_mfma_f32_16x16x32_bf16 v[16:19], v[72:75], v[64:67], v[16:19]
    v_mfma_f32_16x16x32_bf16 v[20:23], v[76:79], v[64:67], v[20:23]
    v_mfma_f32_16x16x32_bf16 v[24:27], v[72:75], v[68:71], v[24:27]
    v_mfma_f32_16x16x32_bf16 v[28:31], v[76:79], v[68:71], v[28:31]
    s_mov_b32 s31, 43008
    buffer_load_dwordx4 v[64:67], v7, s[12:15], s31 offen
    buffer_load_dwordx4 v[68:71], v9, s[12:15], s31 offen
    buffer_load_dwordx4 v[72:75], v8, s[16:19], s31 offen
    buffer_load_dwordx4 v[76:79], v10, s[16:19], s31 offen
    s_waitcnt vmcnt(28)
    v_mfma_f32_16x16x32_bf16 v[16:19], v[88:91], v[80:83], v[16:19]
    v_mfma_f32_16x16x32_bf16 v[20:23], v[92:95], v[80:83], v[20:23]
    v_mfma_f32_16x16x32_bf16 v[24:27], v[88:91], v[84:87], v[24:27]
    v_mfma_f32_16x16x32_bf16 v[28:31], v[92:95], v[84:87], v[28:31]
    s_mov_b32 s31, 44032
    buffer_load_dwordx4 v[80:83], v7, s[12:15], s31 offen
    buffer_load_dwordx4 v[84:87], v9, s[12:15], s31 offen
    buffer_load_dwordx4 v[88:91], v8, s[16:19], s31 offen
    buffer_load_dwordx4 v[92:95], v10, s[16:19], s31 offen
    s_waitcnt vmcnt(28)
    v_mfma_f32_16x16x32_bf16 v[16:19], v[104:107], v[96:99], v[16:19]
    v_mfma_f32_16x16x32_bf16 v[20:23], v[108:111], v[96:99], v[20:23]
    v_mfma_f32_16x16x32_bf16 v[24:27], v[104:107], v[100:103], v[24:27]
    v_mfma_f32_16x16x32_bf16 v[28:31], v[108:111], v[100:103], v[28:31]
    s_mov_b32 s31, 45056
    buffer_load_dwordx4 v[96:99], v7, s[12:15], s31 offen
    buffer_load_dwordx4 v[100:103], v9, s[12:15], s31 offen
    buffer_load_dwordx4 v[104:107], v8, s[16:19], s31 offen
    buffer_load_dwordx4 v[108:111], v10, s[16:19], s31 offen
    s_waitcnt vmcnt(28)
    v_mfma_f32_16x16x32_bf16 v[16:19], v[120:123], v[112:115], v[16:19]
    v_mfma_f32_16x16x32_bf16 v[20:23], v[124:127], v[112:115], v[20:23]
    v_mfma_f32_16x16x32_bf16 v[24:27], v[120:123], v[116:119], v[24:27]
    v_mfma_f32_16x16x32_bf16 v[28:31], v[124:127], v[116:119], v[28:31]
    s_mov_b32 s31, 46080
    buffer_load_dwordx4 v[112:115], v7, s[12:15], s31 offen
    buffer_load_dwordx4 v[116:119], v9, s[12:15], s31 offen
    buffer_load_dwordx4 v[120:123], v8, s[16:19], s31 offen
    buffer_load_dwordx4 v[124:127], v10, s[16:19], s31 offen
    s_waitcnt vmcnt(28)
    v_mfma_f32_16x16x32_bf16 v[16:19], v[136:139], v[128:131], v[16:19]
    v_mfma_f32_16x16x32_bf16 v[20:23], v[140:143], v[128:131], v[20:23]
    v_mfma_f32_16x16x32_bf16 v[24:27], v[136:139], v[132:135], v[24:27]
    v_mfma_f32_16x16x32_bf16 v[28:31], v[140:143], v[132:135], v[28:31]
    s_mov_b32 s31, 47104
    buffer_load_dwordx4 v[128:131], v7, s[12:15], s31 offen
    buffer_load_dwordx4 v[132:135], v9, s[12:15], s31 offen
    buffer_load_dwordx4 v[136:139], v8, s[16:19], s31 offen
    buffer_load_dwordx4 v[140:143], v10, s[16:19], s31 offen
    s_waitcnt vmcnt(28)
    v_mfma_f32_16x16x32_bf16 v[16:19], v[152:155], v[144:147], v[16:19]
    v_mfma_f32_16x16x32_bf16 v[20:23], v[156:159], v[144:147], v[20:23]
    v_mfma_f32_16x16x32_bf16 v[24:27], v[152:155], v[148:151], v[24:27]
    v_mfma_f32_16x16x32_bf16 v[28:31], v[156:159], v[148:151], v[28:31]
    s_mov_b32 s31, 48128
    buffer_load_dwordx4 v[144:147], v7, s[12:15], s31 offen
    buffer_load_dwordx4 v[148:151], v9, s[12:15], s31 offen
    buffer_load_dwordx4 v[152:155], v8, s[16:19], s31 offen
    buffer_load_dwordx4 v[156:159], v10, s[16:19], s31 offen
    s_waitcnt vmcnt(28)
    v_mfma_f32_16x16x32_bf16 v[16:19], v[40:43], v[32:35], v[16:19]
    v_mfma_f32_16x16x32_bf16 v[20:23], v[44:47], v[32:35], v[20:23]
    v_mfma_f32_16x16x32_bf16 v[24:27], v[40:43], v[36:39], v[24:27]
    v_mfma_f32_16x16x32_bf16 v[28:31], v[44:47], v[36:39], v[28:31]
    s_mov_b32 s31, 49152
    buffer_load_dwordx4 v[32:35], v7, s[12:15], s31 offen
    buffer_load_dwordx4 v[36:39], v9, s[12:15], s31 offen
    buffer_load_dwordx4 v[40:43], v8, s[16:19], s31 offen
    buffer_load_dwordx4 v[44:47], v10, s[16:19], s31 offen
    s_waitcnt vmcnt(28)
    v_mfma_f32_16x16x32_bf16 v[16:19], v[56:59], v[48:51], v[16:19]
    v_mfma_f32_16x16x32_bf16 v[20:23], v[60:63], v[48:51], v[20:23]
    v_mfma_f32_16x16x32_bf16 v[24:27], v[56:59], v[52:55], v[24:27]
    v_mfma_f32_16x16x32_bf16 v[28:31], v[60:63], v[52:55], v[28:31]
    s_mov_b32 s31, 50176
    buffer_load_dwordx4 v[48:51], v7, s[12:15], s31 offen
    buffer_load_dwordx4 v[52:55], v9, s[12:15], s31 offen
    buffer_load_dwordx4 v[56:59], v8, s[16:19], s31 offen
    buffer_load_dwordx4 v[60:63], v10, s[16:19], s31 offen
    s_waitcnt vmcnt(28)
    v_mfma_f32_16x16x32_bf16 v[16:19], v[72:75], v[64:67], v[16:19]
    v_mfma_f32_16x16x32_bf16 v[20:23], v[76:79], v[64:67], v[20:23]
    v_mfma_f32_16x16x32_bf16 v[24:27], v[72:75], v[68:71], v[24:27]
    v_mfma_f32_16x16x32_bf16 v[28:31], v[76:79], v[68:71], v[28:31]
    s_mov_b32 s31, 51200
    buffer_load_dwordx4 v[64:67], v7, s[12:15], s31 offen
    buffer_load_dwordx4 v[68:71], v9, s[12:15], s31 offen
    buffer_load_dwordx4 v[72:75], v8, s[16:19], s31 offen
    buffer_load_dwordx4 v[76:79], v10, s[16:19], s31 offen
    s_waitcnt vmcnt(28)
    v_mfma_f32_16x16x32_bf16 v[16:19], v[88:91], v[80:83], v[16:19]
    v_mfma_f32_16x16x32_bf16 v[20:23], v[92:95], v[80:83], v[20:23]
    v_mfma_f32_16x16x32_bf16 v[24:27], v[88:91], v[84:87], v[24:27]
    v_mfma_f32_16x16x32_bf16 v[28:31], v[92:95], v[84:87], v[28:31]
    s_mov_b32 s31, 52224
    buffer_load_dwordx4 v[80:83], v7, s[12:15], s31 offen
    buffer_load_dwordx4 v[84:87], v9, s[12:15], s31 offen
    buffer_load_dwordx4 v[88:91], v8, s[16:19], s31 offen
    buffer_load_dwordx4 v[92:95], v10, s[16:19], s31 offen
    s_waitcnt vmcnt(28)
    v_mfma_f32_16x16x32_bf16 v[16:19], v[104:107], v[96:99], v[16:19]
    v_mfma_f32_16x16x32_bf16 v[20:23], v[108:111], v[96:99], v[20:23]
    v_mfma_f32_16x16x32_bf16 v[24:27], v[104:107], v[100:103], v[24:27]
    v_mfma_f32_16x16x32_bf16 v[28:31], v[108:111], v[100:103], v[28:31]
    s_mov_b32 s31, 53248
    buffer_load_dwordx4 v[96:99], v7, s[12:15], s31 offen
    buffer_load_dwordx4 v[100:103], v9, s[12:15], s31 offen
    buffer_load_dwordx4 v[104:107], v8, s[16:19], s31 offen
    buffer_load_dwordx4 v[108:111], v10, s[16:19], s31 offen
    s_waitcnt vmcnt(28)
    v_mfma_f32_16x16x32_bf16 v[16:19], v[120:123], v[112:115], v[16:19]
    v_mfma_f32_16x16x32_bf16 v[20:23], v[124:127], v[112:115], v[20:23]
    v_mfma_f32_16x16x32_bf16 v[24:27], v[120:123], v[116:119], v[24:27]
    v_mfma_f32_16x16x32_bf16 v[28:31], v[124:127], v[116:119], v[28:31]
    s_mov_b32 s31, 54272
    buffer_load_dwordx4 v[112:115], v7, s[12:15], s31 offen
    buffer_load_dwordx4 v[116:119], v9, s[12:15], s31 offen
    buffer_load_dwordx4 v[120:123], v8, s[16:19], s31 offen
    buffer_load_dwordx4 v[124:127], v10, s[16:19], s31 offen
    s_waitcnt vmcnt(28)
    v_mfma_f32_16x16x32_bf16 v[16:19], v[136:139], v[128:131], v[16:19]
    v_mfma_f32_16x16x32_bf16 v[20:23], v[140:143], v[128:131], v[20:23]
    v_mfma_f32_16x16x32_bf16 v[24:27], v[136:139], v[132:135], v[24:27]
    v_mfma_f32_16x16x32_bf16 v[28:31], v[140:143], v[132:135], v[28:31]
    s_mov_b32 s31, 55296
    buffer_load_dwordx4 v[128:131], v7, s[12:15], s31 offen
    buffer_load_dwordx4 v[132:135], v9, s[12:15], s31 offen
    buffer_load_dwordx4 v[136:139], v8, s[16:19], s31 offen
    buffer_load_dwordx4 v[140:143], v10, s[16:19], s31 offen
    s_waitcnt vmcnt(28)
    v_mfma_f32_16x16x32_bf16 v[16:19], v[152:155], v[144:147], v[16:19]
    v_mfma_f32_16x16x32_bf16 v[20:23], v[156:159], v[144:147], v[20:23]
    v_mfma_f32_16x16x32_bf16 v[24:27], v[152:155], v[148:151], v[24:27]
    v_mfma_f32_16x16x32_bf16 v[28:31], v[156:159], v[148:151], v[28:31]
    s_mov_b32 s31, 56320
    buffer_load_dwordx4 v[144:147], v7, s[12:15], s31 offen
    buffer_load_dwordx4 v[148:151], v9, s[12:15], s31 offen
    buffer_load_dwordx4 v[152:155], v8, s[16:19], s31 offen
    buffer_load_dwordx4 v[156:159], v10, s[16:19], s31 offen
    s_waitcnt vmcnt(28)
    v_mfma_f32_16x16x32_bf16 v[16:19], v[40:43], v[32:35], v[16:19]
    v_mfma_f32_16x16x32_bf16 v[20:23], v[44:47], v[32:35], v[20:23]
    v_mfma_f32_16x16x32_bf16 v[24:27], v[40:43], v[36:39], v[24:27]
    v_mfma_f32_16x16x32_bf16 v[28:31], v[44:47], v[36:39], v[28:31]
    s_waitcnt vmcnt(24)
    v_mfma_f32_16x16x32_bf16 v[16:19], v[56:59], v[48:51], v[16:19]
    v_mfma_f32_16x16x32_bf16 v[20:23], v[60:63], v[48:51], v[20:23]
    v_mfma_f32_16x16x32_bf16 v[24:27], v[56:59], v[52:55], v[24:27]
    v_mfma_f32_16x16x32_bf16 v[28:31], v[60:63], v[52:55], v[28:31]
    s_waitcnt vmcnt(20)
    v_mfma_f32_16x16x32_bf16 v[16:19], v[72:75], v[64:67], v[16:19]
    v_mfma_f32_16x16x32_bf16 v[20:23], v[76:79], v[64:67], v[20:23]
    v_mfma_f32_16x16x32_bf16 v[24:27], v[72:75], v[68:71], v[24:27]
    v_mfma_f32_16x16x32_bf16 v[28:31], v[76:79], v[68:71], v[28:31]
    s_waitcnt vmcnt(16)
    v_mfma_f32_16x16x32_bf16 v[16:19], v[88:91], v[80:83], v[16:19]
    v_mfma_f32_16x16x32_bf16 v[20:23], v[92:95], v[80:83], v[20:23]
    v_mfma_f32_16x16x32_bf16 v[24:27], v[88:91], v[84:87], v[24:27]
    v_mfma_f32_16x16x32_bf16 v[28:31], v[92:95], v[84:87], v[28:31]
    s_waitcnt vmcnt(12)
    v_mfma_f32_16x16x32_bf16 v[16:19], v[104:107], v[96:99], v[16:19]
    v_mfma_f32_16x16x32_bf16 v[20:23], v[108:111], v[96:99], v[20:23]
    v_mfma_f32_16x16x32_bf16 v[24:27], v[104:107], v[100:103], v[24:27]
    v_mfma_f32_16x16x32_bf16 v[28:31], v[108:111], v[100:103], v[28:31]
    s_waitcnt vmcnt(8)
    v_mfma_f32_16x16x32_bf16 v[16:19], v[120:123], v[112:115], v[16:19]
    v_mfma_f32_16x16x32_bf16 v[20:23], v[124:127], v[112:115], v[20:23]
    v_mfma_f32_16x16x32_bf16 v[24:27], v[120:123], v[116:119], v[24:27]
    v_mfma_f32_16x16x32_bf16 v[28:31], v[124:127], v[116:119], v[28:31]
    s_waitcnt vmcnt(4)
    v_mfma_f32_16x16x32_bf16 v[16:19], v[136:139], v[128:131], v[16:19]
    v_mfma_f32_16x16x32_bf16 v[20:23], v[140:143], v[128:131], v[20:23]
    v_mfma_f32_16x16x32_bf16 v[24:27], v[136:139], v[132:135], v[24:27]
    v_mfma_f32_16x16x32_bf16 v[28:31], v[140:143], v[132:135], v[28:31]
    s_waitcnt vmcnt(0)
    v_mfma_f32_16x16x32_bf16 v[16:19], v[152:155], v[144:147], v[16:19]
    v_mfma_f32_16x16x32_bf16 v[20:23], v[156:159], v[144:147], v[20:23]
    v_mfma_f32_16x16x32_bf16 v[24:27], v[152:155], v[148:151], v[24:27]
    v_mfma_f32_16x16x32_bf16 v[28:31], v[156:159], v[148:151], v[28:31]
    s_nop 7
    s_nop 1
    s_mov_b32 s34, 0
    s_mov_b32 s35, 16384
    v_lshl_add_u32 v7, v5, 5, v3
    s_lshl_b32 s30, s28, 6
    v_add_u32 v7, s30, v7
    v_lshlrev_b32 v7, 10, v7
    v_lshlrev_b32 v8, 6, v6
    v_lshl_add_u32 v8, v4, 3, v8
    s_lshl_b32 s30, s29, 7
    v_add_u32 v8, s30, v8
    v_add_u32 v7, v7, v8
    buffer_load_dwordx2 v[40:41], v7, s[20:23], s34 offen offset:0
    buffer_load_dwordx2 v[42:43], v7, s[20:23], s34 offen offset:32
    buffer_load_dwordx2 v[44:45], v7, s[20:23], s35 offen offset:0
    buffer_load_dwordx2 v[46:47], v7, s[20:23], s35 offen offset:32
    s_waitcnt vmcnt(0)
    v_cvt_pk_bf16_f32 v9, v16, v17
    v_lshlrev_b32 v16, 16, v9
    v_and_b32 v17, 0xffff0000, v9
    v_cvt_pk_bf16_f32 v9, v18, v19
    v_lshlrev_b32 v18, 16, v9
    v_and_b32 v19, 0xffff0000, v9
    v_lshlrev_b32 v50, 16, v40
    v_and_b32 v51, 0xffff0000, v40
    v_lshlrev_b32 v52, 16, v41
    v_and_b32 v53, 0xffff0000, v41
    v_add_f32 v16, v16, v50
    v_add_f32 v17, v17, v51
    v_add_f32 v18, v18, v52
    v_add_f32 v19, v19, v53
    v_cvt_pk_bf16_f32 v40, v16, v17
    v_cvt_pk_bf16_f32 v41, v18, v19
    buffer_store_dwordx2 v[40:41], v7, s[24:27], s34 offen offset:0
    v_cvt_pk_bf16_f32 v9, v20, v21
    v_lshlrev_b32 v20, 16, v9
    v_and_b32 v21, 0xffff0000, v9
    v_cvt_pk_bf16_f32 v9, v22, v23
    v_lshlrev_b32 v22, 16, v9
    v_and_b32 v23, 0xffff0000, v9
    v_lshlrev_b32 v50, 16, v42
    v_and_b32 v51, 0xffff0000, v42
    v_lshlrev_b32 v52, 16, v43
    v_and_b32 v53, 0xffff0000, v43
    v_add_f32 v20, v20, v50
    v_add_f32 v21, v21, v51
    v_add_f32 v22, v22, v52
    v_add_f32 v23, v23, v53
    v_cvt_pk_bf16_f32 v42, v20, v21
    v_cvt_pk_bf16_f32 v43, v22, v23
    buffer_store_dwordx2 v[42:43], v7, s[24:27], s34 offen offset:32
    v_cvt_pk_bf16_f32 v9, v24, v25
    v_lshlrev_b32 v24, 16, v9
    v_and_b32 v25, 0xffff0000, v9
    v_cvt_pk_bf16_f32 v9, v26, v27
    v_lshlrev_b32 v26, 16, v9
    v_and_b32 v27, 0xffff0000, v9
    v_lshlrev_b32 v50, 16, v44
    v_and_b32 v51, 0xffff0000, v44
    v_lshlrev_b32 v52, 16, v45
    v_and_b32 v53, 0xffff0000, v45
    v_add_f32 v24, v24, v50
    v_add_f32 v25, v25, v51
    v_add_f32 v26, v26, v52
    v_add_f32 v27, v27, v53
    v_cvt_pk_bf16_f32 v44, v24, v25
    v_cvt_pk_bf16_f32 v45, v26, v27
    buffer_store_dwordx2 v[44:45], v7, s[24:27], s35 offen offset:0
    v_cvt_pk_bf16_f32 v9, v28, v29
    v_lshlrev_b32 v28, 16, v9
    v_and_b32 v29, 0xffff0000, v9
    v_cvt_pk_bf16_f32 v9, v30, v31
    v_lshlrev_b32 v30, 16, v9
    v_and_b32 v31, 0xffff0000, v9
    v_lshlrev_b32 v50, 16, v46
    v_and_b32 v51, 0xffff0000, v46
    v_lshlrev_b32 v52, 16, v47
    v_and_b32 v53, 0xffff0000, v47
    v_add_f32 v28, v28, v50
    v_add_f32 v29, v29, v51
    v_add_f32 v30, v30, v52
    v_add_f32 v31, v31, v53
    v_cvt_pk_bf16_f32 v46, v28, v29
    v_cvt_pk_bf16_f32 v47, v30, v31
    buffer_store_dwordx2 v[46:47], v7, s[24:27], s35 offen offset:32
g2_end:
    s_endpgm
.section .rodata,"a"
.p2align 6
.amdhsa_kernel kv_kernel
  .amdhsa_next_free_vgpr 96
  .amdhsa_next_free_sgpr 102
  .amdhsa_accum_offset 96
  .amdhsa_group_segment_fixed_size 0
  .amdhsa_kernarg_size 104
  .amdhsa_user_sgpr_count 2
  .amdhsa_user_sgpr_kernarg_segment_ptr 1
  .amdhsa_system_sgpr_workgroup_id_x 1
.end_amdhsa_kernel
.p2align 6
.amdhsa_kernel conv_kernel
  .amdhsa_next_free_vgpr 212
  .amdhsa_next_free_sgpr 102
  .amdhsa_accum_offset 212
  .amdhsa_group_segment_fixed_size 0
  .amdhsa_kernarg_size 104
  .amdhsa_user_sgpr_count 2
  .amdhsa_user_sgpr_kernarg_segment_ptr 1
  .amdhsa_system_sgpr_workgroup_id_x 1
.end_amdhsa_kernel
.p2align 6
.amdhsa_kernel ln_kernel
  .amdhsa_next_free_vgpr 136
  .amdhsa_next_free_sgpr 102
  .amdhsa_accum_offset 136
  .amdhsa_group_segment_fixed_size 0
  .amdhsa_kernarg_size 104
  .amdhsa_user_sgpr_count 2
  .amdhsa_user_sgpr_kernarg_segment_ptr 1
  .amdhsa_system_sgpr_workgroup_id_x 1
.end_amdhsa_kernel
.p2align 6
.amdhsa_kernel g1_kernel
  .amdhsa_next_free_vgpr 336
  .amdhsa_next_free_sgpr 102
  .amdhsa_accum_offset 208
  .amdhsa_group_segment_fixed_size 0
  .amdhsa_kernarg_size 104
  .amdhsa_user_sgpr_count 2
  .amdhsa_user_sgpr_kernarg_segment_ptr 1
  .amdhsa_system_sgpr_workgroup_id_x 1
.end_amdhsa_kernel
.p2align 6
.amdhsa_kernel g2_kernel
  .amdhsa_next_free_vgpr 160
  .amdhsa_next_free_sgpr 102
  .amdhsa_accum_offset 160
  .amdhsa_group_segment_fixed_size 0
  .amdhsa_kernarg_size 104
  .amdhsa_user_sgpr_count 2
  .amdhsa_user_sgpr_kernarg_segment_ptr 1
  .amdhsa_system_sgpr_workgroup_id_x 1
.end_amdhsa_kernel
```
